```python
import torch

def _softmax(x, axis=-1):
    return torch.softmax(x, dim=axis)
def _gelu(x):
    return torch.nn.functional.gelu(x, approximate="tanh")
def _silu(x):
    return torch.nn.functional.silu(x)
def _sigmoid(x):
    return torch.sigmoid(x)
def _layernorm(x, axis=-1, eps=1e-5):
    m = x.mean(dim=axis, keepdim=True)
    v = x.var(dim=axis, keepdim=True, unbiased=False)
    return (x - m) / torch.sqrt(v + eps)
def _scatter_add(tgt, idx, src, axis=0):
    return tgt.clone().index_add_(axis, idx, src)
def _segment_sum(src, seg, n):
    out = torch.zeros((n,) + src.shape[1:], dtype=src.dtype)
    return out.index_add_(0, seg, src)
def _pad(x, pw):
    flat = tuple(v for pair in reversed(pw) for v in pair)
    return torch.nn.functional.pad(x, flat)

kernel_name = 'gated_mix__gqa_block_cached__geglu_ffn__decode'

def setup_inputs():

    _w = (lambda a: (lambda t: t.to(torch.bfloat16) if t.is_floating_point() else t)(torch.as_tensor(a)))
    def _A_setup():
        B, Sq, D = 2, 1, 640
        Hq, Hkv, Sk, Dh = 32, 32, 8192, 128
        assert Hq % Hkv == 0, (Hq, Hkv)
        return {
            "x": _w((lambda *s: torch.randn(*s, dtype=torch.bfloat16) * 0.05)(B, Sq, D)),
            "k_cache": _w((lambda *s: torch.randn(*s, dtype=torch.bfloat16) * 6.4)(B, Hkv, Sk, Dh)),
            "v_cache": _w((lambda *s: torch.randn(*s, dtype=torch.bfloat16) * 0.2)(B, Hkv, Sk, Dh)),
            "wq": _w((lambda *s: torch.randn(*s, dtype=torch.bfloat16) * 6.4)(D, Hq * Dh) * (D ** -0.5)),
            "wo": _w((lambda *s: torch.randn(*s, dtype=torch.bfloat16) * 0.2)(Hq * Dh, D) * ((Hq * Dh) ** -0.5)),
        }
    _A_in = _A_setup()

    def _B_setup():
        B, S, D, F = 2, 1, 640, 1728
        return {
            "x": _w((lambda *s: torch.randn(*s, dtype=torch.bfloat16) * 0.05)(B, S, D)),
            "w_gate": _w((lambda *s: torch.randn(*s, dtype=torch.bfloat16) * 0.05)(D, F)),
            "w_up": _w((lambda *s: torch.randn(*s, dtype=torch.bfloat16) * 0.05)(D, F)),
            "w_down": _w((lambda *s: torch.randn(*s, dtype=torch.bfloat16) * 0.05)(F, D)),
        }
    _B_in = _B_setup()

    return {
        "A_x": _A_in["x"],
        "A_k_cache": _A_in["k_cache"],
        "A_v_cache": _A_in["v_cache"],
        "A_wq": _A_in["wq"],
        "A_wo": _A_in["wo"],
        "B_x": _B_in["x"],
        "B_w_gate": _B_in["w_gate"],
        "B_w_up": _B_in["w_up"],
        "B_w_down": _B_in["w_down"],
        "gate_w": _w((lambda *s: torch.randn(*s, dtype=torch.bfloat16) * 0.05)(640) * 16.0),
    }

def reference(A_x, A_k_cache, A_v_cache, A_wq, A_wo, B_x, B_w_gate, B_w_up, B_w_down, gate_w):
    def _A_ref(x, k_cache, v_cache, wq, wo):
        B, Sq, D = x.shape
        Hq, Dh = 32, 128
        Hkv = k_cache.shape[1]
        rep = Hq // Hkv
        q = (lambda x, *d: x.permute(*d))((x @ wq).reshape(B, Sq, Hq, Dh), 0, 2, 1, 3)
        k = (lambda x, n, axis: torch.repeat_interleave(x, n, dim=axis))(k_cache, rep, axis=1)
        v = (lambda x, n, axis: torch.repeat_interleave(x, n, dim=axis))(v_cache, rep, axis=1)
        scores = torch.einsum("bhqd,bhkd->bhqk", q, k) * (Dh ** -0.5)
        p = _softmax(scores, axis=-1)
        o = torch.einsum("bhqk,bhkd->bhqd", p, v)
        return (lambda x, *d: x.permute(*d))(o, 0, 2, 1, 3).reshape(B, Sq, Hq * Dh) @ wo

    def _B_ref(x, w_gate, w_up, w_down):
        return (_gelu(x @ w_gate) * (x @ w_up)) @ w_down

    x = A_x
    g = _sigmoid((x * gate_w).sum(-1, keepdims=True))
    a = _A_ref(x, A_k_cache, A_v_cache, A_wq, A_wo)
    b = _B_ref(x, B_w_gate, B_w_up, B_w_down)
    return g * a + (1 - g) * b
```

```asm
; @launch grid=(256,1,1) block=(512,1,1) lds=6144
.amdgcn_target "amdgcn-amd-amdhsa--gfx950"
.text
.globl gated_mix__gqa_block_cached__geglu_ffn__decode_kernel
.p2align 8
.type gated_mix__gqa_block_cached__geglu_ffn__decode_kernel,@function
gated_mix__gqa_block_cached__geglu_ffn__decode_kernel:
    s_cmp_ge_u32 s2, 256
    s_cbranch_scc1 L_end
    s_load_dwordx16 s[4:19], s[0:1], 0
    s_load_dwordx8 s[20:27], s[0:1], 64
    s_load_dwordx2 s[28:29], s[0:1], 96
    v_lshrrev_b32 v1, 6, v0
    v_and_b32 v2, 15, v0
    v_readfirstlane_b32 s3, v1
    v_and_b32 v1, 63, v0
    v_lshrrev_b32 v3, 4, v1
    s_and_b32 s34, s2, 7
    s_lshr_b32 s56, s2, 6
    s_lshl_b32 s56, s56, 3
    s_add_u32 s30, s34, s56
    s_lshr_b32 s38, s2, 3
    s_and_b32 s38, s38, 7
    s_and_b32 s32, s38, 3
    s_lshr_b32 s31, s38, 2
    s_lshl_b32 s33, s31, 5
    s_add_u32 s33, s33, s30
    s_mov_b32 s35, 0x05040100
    s_mov_b32 s36, 0x07060302
    s_movk_i32 s37, 0x1ff
    s_mov_b32 s43, 0x20000
    s_mov_b32 s47, 0x20000
    s_mov_b32 s51, 0x20000
    s_mov_b32 s55, 0x20000
    s_mov_b32 s46, 2752512
    s_mov_b32 s77, s3
    s_cmp_ge_u32 s3, 4
    s_cbranch_scc1 L_stream
    s_setprio 1
    s_lshr_b32 s63, s2, 3
    s_bfe_u32 s64, s2, 0x10002
    s_and_b32 s65, s2, 3
    s_movk_i32 s56, 3456
    s_lshl_b32 s57, s63, 7
    s_movk_i32 s59, 256
    s_movk_i32 s61, 32
    s_movk_i32 s71, 16
    s_lshl_b32 s62, s2, 9
    s_add_u32 s62, s62, 393216
    s_mov_b32 s42, 2211840
    s_cmp_lg_u32 s3, 0
    s_cbranch_scc1 L_h_notq
    s_movk_i32 s56, 8192
    s_lshl_b32 s57, s30, 8
    s_lshl_b32 s66, s31, 7
    s_add_u32 s57, s57, s66
    s_mov_b32 s59, 65536
    s_movk_i32 s61, 16
    s_movk_i32 s71, 1024
    s_lshl_b32 s62, s30, 11
    s_add_u32 s62, s62, s66
    s_lshl_b32 s66, s32, 8
    s_add_u32 s62, s62, s66
    s_add_u32 s62, s62, 65536
    s_mov_b32 s42, 5242880
    s_mov_b32 s65, s32
L_h_notq:
    s_mul_i32 s66, s65, 160
    s_mul_i32 s66, s66, s56
    s_add_u32 s57, s57, s66
    s_mul_i32 s58, s65, 320
    s_mul_i32 s67, s56, 25
    v_lshlrev_b32 v5, 3, v3
    v_mul_lo_u32 v5, v5, s56
    v_lshl_add_u32 v5, v2, 3, v5
    v_lshrrev_b32 v6, 3, v2
    v_mul_u32_u24 v6, 1280, v6
    v_lshl_add_u32 v6, v3, 4, v6
    v_mov_b32 v7, 0
    s_movk_i32 s50, 2560
    s_cmp_eq_u32 s3, 0
    s_cselect_b32 s66, 0, s2
    s_cmp_ge_u32 s3, 2
    s_cselect_b32 s66, 255, s66
    s_waitcnt lgkmcnt(0)
    s_mov_b32 s44, s28
    s_mov_b32 s45, s29
    s_mov_b32 s48, s4
    s_mov_b32 s49, s5
    s_cmp_eq_u32 s64, 0
    s_cselect_b32 s40, s16, s18
    s_cselect_b32 s41, s17, s19
    s_cmp_eq_u32 s3, 0
    s_cselect_b32 s40, s10, s40
    s_cselect_b32 s41, s11, s41
    s_cmp_ge_u32 s66, 216
    s_cbranch_scc1 L_h_idle0
    buffer_load_dwordx4 v[96:99], v6, s[48:51], s58 offen offset:0
    buffer_load_dwordx2 v[16:17], v5, s[40:43], s57 offen nt
    s_add_u32 s57, s57, s56
    buffer_load_dwordx2 v[18:19], v5, s[40:43], s57 offen nt
    s_add_u32 s57, s57, s56
    buffer_load_dwordx2 v[20:21], v5, s[40:43], s57 offen nt
    s_add_u32 s57, s57, s56
    buffer_load_dwordx2 v[22:23], v5, s[40:43], s57 offen nt
    s_add_u32 s57, s57, s56
    buffer_load_dwordx2 v[24:25], v5, s[40:43], s57 offen nt
    s_add_u32 s57, s57, s56
    buffer_load_dwordx2 v[26:27], v5, s[40:43], s57 offen nt
    s_add_u32 s57, s57, s56
    buffer_load_dwordx2 v[28:29], v5, s[40:43], s57 offen nt
    s_add_u32 s57, s57, s56
    buffer_load_dwordx2 v[30:31], v5, s[40:43], s57 offen nt
    s_add_u32 s57, s57, s67
    buffer_load_dwordx4 v[100:103], v6, s[48:51], s58 offen offset:64
    buffer_load_dwordx2 v[32:33], v5, s[40:43], s57 offen nt
    s_add_u32 s57, s57, s56
    buffer_load_dwordx2 v[34:35], v5, s[40:43], s57 offen nt
    s_add_u32 s57, s57, s56
    buffer_load_dwordx2 v[36:37], v5, s[40:43], s57 offen nt
    s_add_u32 s57, s57, s56
    buffer_load_dwordx2 v[38:39], v5, s[40:43], s57 offen nt
    s_add_u32 s57, s57, s56
    buffer_load_dwordx2 v[40:41], v5, s[40:43], s57 offen nt
    s_add_u32 s57, s57, s56
    buffer_load_dwordx2 v[42:43], v5, s[40:43], s57 offen nt
    s_add_u32 s57, s57, s56
    buffer_load_dwordx2 v[44:45], v5, s[40:43], s57 offen nt
    s_add_u32 s57, s57, s56
    buffer_load_dwordx2 v[46:47], v5, s[40:43], s57 offen nt
    s_add_u32 s57, s57, s67
    buffer_load_dwordx4 v[104:107], v6, s[48:51], s58 offen offset:128
    buffer_load_dwordx2 v[48:49], v5, s[40:43], s57 offen nt
    s_add_u32 s57, s57, s56
    buffer_load_dwordx2 v[50:51], v5, s[40:43], s57 offen nt
    s_add_u32 s57, s57, s56
    buffer_load_dwordx2 v[52:53], v5, s[40:43], s57 offen nt
    s_add_u32 s57, s57, s56
    buffer_load_dwordx2 v[54:55], v5, s[40:43], s57 offen nt
    s_add_u32 s57, s57, s56
    buffer_load_dwordx2 v[56:57], v5, s[40:43], s57 offen nt
    s_add_u32 s57, s57, s56
    buffer_load_dwordx2 v[58:59], v5, s[40:43], s57 offen nt
    s_add_u32 s57, s57, s56
    buffer_load_dwordx2 v[60:61], v5, s[40:43], s57 offen nt
    s_add_u32 s57, s57, s56
    buffer_load_dwordx2 v[62:63], v5, s[40:43], s57 offen nt
    s_add_u32 s57, s57, s67
    buffer_load_dwordx4 v[108:111], v6, s[48:51], s58 offen offset:192
    buffer_load_dwordx2 v[64:65], v5, s[40:43], s57 offen nt
    s_add_u32 s57, s57, s56
    buffer_load_dwordx2 v[66:67], v5, s[40:43], s57 offen nt
    s_add_u32 s57, s57, s56
    buffer_load_dwordx2 v[68:69], v5, s[40:43], s57 offen nt
    s_add_u32 s57, s57, s56
    buffer_load_dwordx2 v[70:71], v5, s[40:43], s57 offen nt
    s_add_u32 s57, s57, s56
    buffer_load_dwordx2 v[72:73], v5, s[40:43], s57 offen nt
    s_add_u32 s57, s57, s56
    buffer_load_dwordx2 v[74:75], v5, s[40:43], s57 offen nt
    s_add_u32 s57, s57, s56
    buffer_load_dwordx2 v[76:77], v5, s[40:43], s57 offen nt
    s_add_u32 s57, s57, s56
    buffer_load_dwordx2 v[78:79], v5, s[40:43], s57 offen nt
    s_add_u32 s57, s57, s67
    buffer_load_dwordx4 v[112:115], v6, s[48:51], s58 offen offset:256
    buffer_load_dwordx2 v[80:81], v5, s[40:43], s57 offen nt
    s_add_u32 s57, s57, s56
    buffer_load_dwordx2 v[82:83], v5, s[40:43], s57 offen nt
    s_add_u32 s57, s57, s56
    buffer_load_dwordx2 v[84:85], v5, s[40:43], s57 offen nt
    s_add_u32 s57, s57, s56
    buffer_load_dwordx2 v[86:87], v5, s[40:43], s57 offen nt
    s_add_u32 s57, s57, s56
    buffer_load_dwordx2 v[88:89], v5, s[40:43], s57 offen nt
    s_add_u32 s57, s57, s56
    buffer_load_dwordx2 v[90:91], v5, s[40:43], s57 offen nt
    s_add_u32 s57, s57, s56
    buffer_load_dwordx2 v[92:93], v5, s[40:43], s57 offen nt
    s_add_u32 s57, s57, s56
    buffer_load_dwordx2 v[94:95], v5, s[40:43], s57 offen nt
    s_add_u32 s57, s57, s67
    buffer_load_dword v4, v7, s[44:47], 0 offen offset:0 sc1
    s_barrier
    v_lshrrev_b32 v8, 1, v3
    v_mul_lo_u32 v8, v8, s59
    v_lshrrev_b32 v9, 1, v2
    v_mul_lo_u32 v9, v9, s61
    v_add_u32 v8, v8, v9
    v_and_b32 v9, 1, v2
    v_mul_lo_u32 v9, v9, s71
    v_add_u32 v8, v8, v9
    s_waitcnt vmcnt(37)
    v_perm_b32 v116, v18, v16, s35
    v_perm_b32 v117, v22, v20, s35
    v_perm_b32 v118, v26, v24, s35
    v_perm_b32 v119, v30, v28, s35
    v_perm_b32 v120, v18, v16, s36
    v_perm_b32 v121, v22, v20, s36
    v_perm_b32 v122, v26, v24, s36
    v_perm_b32 v123, v30, v28, s36
    v_perm_b32 v124, v19, v17, s35
    v_perm_b32 v125, v23, v21, s35
    v_perm_b32 v126, v27, v25, s35
    v_perm_b32 v127, v31, v29, s35
    v_perm_b32 v128, v19, v17, s36
    v_perm_b32 v129, v23, v21, s36
    v_perm_b32 v130, v27, v25, s36
    v_perm_b32 v131, v31, v29, s36
    v_mfma_f32_16x16x32_bf16 v[132:135], v[96:99], v[116:119], 0
    v_mfma_f32_16x16x32_bf16 v[136:139], v[96:99], v[120:123], 0
    v_mfma_f32_16x16x32_bf16 v[140:143], v[96:99], v[124:127], 0
    v_mfma_f32_16x16x32_bf16 v[144:147], v[96:99], v[128:131], 0
    s_waitcnt vmcnt(28)
    v_perm_b32 v116, v34, v32, s35
    v_perm_b32 v117, v38, v36, s35
    v_perm_b32 v118, v42, v40, s35
    v_perm_b32 v119, v46, v44, s35
    v_perm_b32 v120, v34, v32, s36
    v_perm_b32 v121, v38, v36, s36
    v_perm_b32 v122, v42, v40, s36
    v_perm_b32 v123, v46, v44, s36
    v_perm_b32 v124, v35, v33, s35
    v_perm_b32 v125, v39, v37, s35
    v_perm_b32 v126, v43, v41, s35
    v_perm_b32 v127, v47, v45, s35
    v_perm_b32 v128, v35, v33, s36
    v_perm_b32 v129, v39, v37, s36
    v_perm_b32 v130, v43, v41, s36
    v_perm_b32 v131, v47, v45, s36
    v_mfma_f32_16x16x32_bf16 v[132:135], v[100:103], v[116:119], v[132:135]
    v_mfma_f32_16x16x32_bf16 v[136:139], v[100:103], v[120:123], v[136:139]
    v_mfma_f32_16x16x32_bf16 v[140:143], v[100:103], v[124:127], v[140:143]
    v_mfma_f32_16x16x32_bf16 v[144:147], v[100:103], v[128:131], v[144:147]
    s_waitcnt vmcnt(19)
    v_perm_b32 v116, v50, v48, s35
    v_perm_b32 v117, v54, v52, s35
    v_perm_b32 v118, v58, v56, s35
    v_perm_b32 v119, v62, v60, s35
    v_perm_b32 v120, v50, v48, s36
    v_perm_b32 v121, v54, v52, s36
    v_perm_b32 v122, v58, v56, s36
    v_perm_b32 v123, v62, v60, s36
    v_perm_b32 v124, v51, v49, s35
    v_perm_b32 v125, v55, v53, s35
    v_perm_b32 v126, v59, v57, s35
    v_perm_b32 v127, v63, v61, s35
    v_perm_b32 v128, v51, v49, s36
    v_perm_b32 v129, v55, v53, s36
    v_perm_b32 v130, v59, v57, s36
    v_perm_b32 v131, v63, v61, s36
    v_mfma_f32_16x16x32_bf16 v[132:135], v[104:107], v[116:119], v[132:135]
    v_mfma_f32_16x16x32_bf16 v[136:139], v[104:107], v[120:123], v[136:139]
    v_mfma_f32_16x16x32_bf16 v[140:143], v[104:107], v[124:127], v[140:143]
    v_mfma_f32_16x16x32_bf16 v[144:147], v[104:107], v[128:131], v[144:147]
    s_waitcnt vmcnt(10)
    v_perm_b32 v116, v66, v64, s35
    v_perm_b32 v117, v70, v68, s35
    v_perm_b32 v118, v74, v72, s35
    v_perm_b32 v119, v78, v76, s35
    v_perm_b32 v120, v66, v64, s36
    v_perm_b32 v121, v70, v68, s36
    v_perm_b32 v122, v74, v72, s36
    v_perm_b32 v123, v78, v76, s36
    v_perm_b32 v124, v67, v65, s35
    v_perm_b32 v125, v71, v69, s35
    v_perm_b32 v126, v75, v73, s35
    v_perm_b32 v127, v79, v77, s35
    v_perm_b32 v128, v67, v65, s36
    v_perm_b32 v129, v71, v69, s36
    v_perm_b32 v130, v75, v73, s36
    v_perm_b32 v131, v79, v77, s36
    v_mfma_f32_16x16x32_bf16 v[132:135], v[108:111], v[116:119], v[132:135]
    v_mfma_f32_16x16x32_bf16 v[136:139], v[108:111], v[120:123], v[136:139]
    v_mfma_f32_16x16x32_bf16 v[140:143], v[108:111], v[124:127], v[140:143]
    v_mfma_f32_16x16x32_bf16 v[144:147], v[108:111], v[128:131], v[144:147]
    s_waitcnt vmcnt(1)
    v_perm_b32 v116, v82, v80, s35
    v_perm_b32 v117, v86, v84, s35
    v_perm_b32 v118, v90, v88, s35
    v_perm_b32 v119, v94, v92, s35
    v_perm_b32 v120, v82, v80, s36
    v_perm_b32 v121, v86, v84, s36
    v_perm_b32 v122, v90, v88, s36
    v_perm_b32 v123, v94, v92, s36
    v_perm_b32 v124, v83, v81, s35
    v_perm_b32 v125, v87, v85, s35
    v_perm_b32 v126, v91, v89, s35
    v_perm_b32 v127, v95, v93, s35
    v_perm_b32 v128, v83, v81, s36
    v_perm_b32 v129, v87, v85, s36
    v_perm_b32 v130, v91, v89, s36
    v_perm_b32 v131, v95, v93, s36
    v_mfma_f32_16x16x32_bf16 v[132:135], v[112:115], v[116:119], v[132:135]
    v_mfma_f32_16x16x32_bf16 v[136:139], v[112:115], v[120:123], v[136:139]
    v_mfma_f32_16x16x32_bf16 v[140:143], v[112:115], v[124:127], v[140:143]
    v_mfma_f32_16x16x32_bf16 v[144:147], v[112:115], v[128:131], v[144:147]
    s_waitcnt vmcnt(0)
    v_add_u32 v4, 1, v4
    v_mov_b32 v249, 0x9e3779b1
    v_mov_b32 v246, v4
    v_mul_lo_u32 v249, v249, v4
    v_lshrrev_b32 v247, 9, v249
    v_lshrrev_b32 v248, 18, v249
    v_lshrrev_b32 v249, 23, v249
    v_add_u32 v12, 0x100, v132
    v_add_u32 v13, 0x100, v136
    v_add_u32 v14, 0x100, v140
    v_add_u32 v15, 0x100, v144
    v_bfi_b32 v12, s37, v246, v12
    v_bfi_b32 v13, s37, v247, v13
    v_bfi_b32 v14, s37, v248, v14
    v_bfi_b32 v15, s37, v249, v15
    s_mov_b32 exec_lo, 0xffff
    s_mov_b32 exec_hi, 0xffff
    buffer_store_dwordx4 v[12:15], v8, s[44:47], s62 offen sc1
    s_mov_b64 exec, -1
    s_cmp_lg_u32 s3, 0
    s_cbranch_scc1 L_h_b
    v_lshlrev_b32 v5, 4, v1
    s_lshl_b32 s56, s33, 11
    s_add_u32 s56, s56, 65536
    s_mov_b32 s57, 960000
L_pw:
    s_nop 4
    ds_read_b32 v10, v7 offset:1156
    s_waitcnt lgkmcnt(0)
    v_cmp_ne_u32 vcc, 1, v10
    s_cbranch_vccz L_pw_ok
    s_sleep 2
    s_sub_u32 s57, s57, 1
    s_cbranch_scc0 L_pw
L_pw_ok:
    s_mov_b32 s57, 60000
L_pq:
    s_nop 4
    buffer_load_dwordx4 v[148:151], v5, s[44:47], s56 offen offset:0 sc1
    buffer_load_dwordx4 v[152:155], v5, s[44:47], s56 offen offset:1024 sc1
    s_mov_b64 exec, -1
    s_waitcnt vmcnt(0)
    v_xor_b32 v10, v148, v246
    v_bitop3_b32 v10, v149, v247, v10 bitop3:0xbe
    v_bitop3_b32 v10, v150, v248, v10 bitop3:0xbe
    v_bitop3_b32 v10, v151, v249, v10 bitop3:0xbe
    v_bitop3_b32 v10, v152, v246, v10 bitop3:0xbe
    v_bitop3_b32 v10, v153, v247, v10 bitop3:0xbe
    v_bitop3_b32 v10, v154, v248, v10 bitop3:0xbe
    v_bitop3_b32 v10, v155, v249, v10 bitop3:0xbe
    v_and_b32 v10, 0x1ff, v10
    v_cmp_ne_u32 vcc, 0, v10
    s_sub_u32 s57, s57, 1
    s_cbranch_scc1 L_pq_ok
    s_cbranch_vccz L_pq_ok
    s_sleep 1
    s_mov_b64 exec, vcc
    s_branch L_pq
L_pq_ok:
    v_and_b32 v148, 0xfffffe00, v148
    v_and_b32 v149, 0xfffffe00, v149
    v_and_b32 v150, 0xfffffe00, v150
    v_and_b32 v151, 0xfffffe00, v151
    v_and_b32 v152, 0xfffffe00, v152
    v_and_b32 v153, 0xfffffe00, v153
    v_and_b32 v154, 0xfffffe00, v154
    v_and_b32 v155, 0xfffffe00, v155
    v_permlane32_swap_b32 v148, v152
    v_permlane32_swap_b32 v149, v153
    v_permlane32_swap_b32 v150, v154
    v_permlane32_swap_b32 v151, v155
    v_add_f32 v148, v148, v152
    v_add_f32 v149, v149, v153
    v_add_f32 v150, v150, v154
    v_add_f32 v151, v151, v155
    s_nop 0
    v_permlane16_swap_b32 v148, v150
    v_permlane16_swap_b32 v149, v151
    v_add_f32 v148, v148, v150
    v_add_f32 v149, v149, v151
    v_cvt_pk_bf16_f32 v10, v148, v149
    v_lshlrev_b32 v9, 4, v2
    v_lshl_add_u32 v9, v3, 2, v9
    ds_write_b32 v9, v10 offset:0
    v_mov_b32 v10, 1
    v_mov_b32 v11, v4
    s_waitcnt lgkmcnt(0)
    ds_write_b64 v7, v[10:11] offset:1088
    v_lshrrev_b32 v200, 3, v1
    v_mul_u32_u24 v200, 2560, v200
    v_and_b32 v201, 7, v1
    v_lshl_add_u32 v200, v201, 4, v200
    s_cmp_ge_u32 s2, 20
    s_cselect_b32 s76, 325120, 0
    s_lshl_b32 s56, s2, 7
    s_add_u32 s76, s76, s56
    s_mul_i32 s56, s77, 40960
    s_add_u32 s76, s76, s56
    s_add_u32 s76, s76, 2097152
    s_add_u32 s79, s76, 20480
    s_lshl_b32 s56, s77, 7
    v_lshl_add_u32 v201, v201, 4, s56
    v_lshrrev_b32 v202, 4, v1
    v_lshl_add_u32 v201, v202, 2, v201
    s_cmp_ge_u32 s2, 20
    s_cselect_b32 s58, 640, 0
    s_cselect_b32 s57, 20, 0
    s_sub_u32 s57, s2, s57
    s_bfe_u32 s56, s57, 0x10002
    s_mul_i32 s56, s56, 1280
    s_lshr_b32 s59, s57, 3
    s_lshl_b32 s59, s59, 8
    s_add_u32 s56, s56, s59
    s_and_b32 s59, s57, 1
    s_lshl_b32 s59, s59, 7
    s_add_u32 s56, s56, s59
    s_bfe_u32 s59, s57, 0x10001
    s_lshl_b32 s59, s59, 3
    s_add_u32 s78, s56, s59
    s_bfe_u32 s56, s57, 0x10001
    s_mul_i32 s56, s56, 1280
    s_and_b32 s59, s57, 1
    s_lshl_b32 s59, s59, 3
    s_add_u32 s56, s56, s59
    s_add_u32 s56, s56, 512
    s_cmp_ge_u32 s57, 16
    s_cselect_b32 s78, s56, s78
    s_add_u32 s78, s78, s58
    v_and_b32 v8, 7, v1
    v_lshrrev_b32 v9, 5, v1
    v_lshlrev_b32 v9, 2, v9
    v_lshl_add_u32 v170, v8, 4, v9
    s_lshl_b32 s75, s33, 11
    s_lshl_b32 s56, s32, 9
    s_add_u32 s75, s75, s56
    s_add_u32 s75, s75, 1048576
    v_and_b32 v8, 3, v1
    v_lshlrev_b32 v11, 7, v8
    v_lshlrev_b32 v8, 4, v8
    s_lshl_b32 s56, s33, 9
    s_add_u32 s56, s56, 655360
    s_lshl_b32 s59, s32, 7
    v_mov_b32 v9, s59
    s_mov_b32 s58, 0x3fb8aa3b
    s_mov_b32 s57, 960000
L_pl:
    s_nop 4
    ds_read_b128 v[152:155], v8 offset:1024
    s_waitcnt lgkmcnt(0)
    v_cmp_ne_u32 vcc, 1, v154
    s_cbranch_vccz L_pl_ok
    s_sleep 4
    s_sub_u32 s57, s57, 1
    s_cbranch_scc0 L_pl
L_pl_ok:
    v_mov_b32 v156, v152
    s_nop 1
    v_max_f32_dpp v156, v156, v156 quad_perm:[1,0,3,2] row_mask:0xf bank_mask:0xf
    s_nop 1
    v_max_f32_dpp v156, v156, v156 quad_perm:[2,3,0,1] row_mask:0xf bank_mask:0xf
    v_sub_f32 v160, v152, v156
    v_mul_f32 v160, s58, v160
    v_exp_f32 v160, v160
    s_nop 0
    v_mul_f32 v157, v153, v160
    s_nop 1
    v_add_f32_dpp v157, v157, v157 quad_perm:[1,0,3,2] row_mask:0xf bank_mask:0xf
    s_nop 1
    v_add_f32_dpp v157, v157, v157 quad_perm:[2,3,0,1] row_mask:0xf bank_mask:0xf
    v_and_b32 v158, 0xffff0000, v157
    v_sub_f32 v159, v157, v158
    v_bfi_b32 v156, s37, v246, v156
    v_bfi_b32 v157, s37, v247, v158
    v_bfi_b32 v158, s37, v248, v159
    v_and_b32 v159, 0x1ff, v249
    s_mov_b64 exec, 1
    buffer_store_dwordx4 v[156:159], v9, s[44:47], s56 offen sc1
    s_mov_b64 exec, -1
    s_mov_b32 s57, 960000
L_pv:
    s_nop 4
    ds_read_b32 v10, v7 offset:1152
    s_waitcnt lgkmcnt(0)
    v_cmp_ne_u32 vcc, 1, v10
    s_cbranch_vccz L_pv_ok
    s_sleep 16
    s_sub_u32 s57, s57, 1
    s_cbranch_scc0 L_pv
L_pv_ok:
    s_mov_b32 s57, 60000
L_pm:
    s_nop 4
    buffer_load_dwordx4 v[160:163], v11, s[44:47], s56 offen offset:0 sc1
    s_mov_b64 exec, -1
    s_waitcnt vmcnt(0)
    v_xor_b32 v10, v160, v246
    v_bitop3_b32 v10, v161, v247, v10 bitop3:0xbe
    v_bitop3_b32 v10, v162, v248, v10 bitop3:0xbe
    v_bitop3_b32 v10, v163, v249, v10 bitop3:0xbe
    v_and_b32 v10, 0x1ff, v10
    v_cmp_ne_u32 vcc, 0, v10
    s_sub_u32 s57, s57, 1
    s_cbranch_scc1 L_pm_ok
    s_cbranch_vccz L_pm_ok
    s_sleep 8
    s_mov_b64 exec, vcc
    s_branch L_pm
L_pm_ok:
    v_and_b32 v160, 0xfffffe00, v160
    v_and_b32 v161, 0xfffffe00, v161
    v_and_b32 v162, 0xfffffe00, v162
    v_add_f32 v161, v161, v162
    v_mov_b32 v162, v160
    s_nop 1
    v_max_f32_dpp v162, v162, v162 quad_perm:[1,0,3,2] row_mask:0xf bank_mask:0xf
    s_nop 1
    v_max_f32_dpp v162, v162, v162 quad_perm:[2,3,0,1] row_mask:0xf bank_mask:0xf
    v_sub_f32 v164, v160, v162
    v_mul_f32 v164, s58, v164
    v_exp_f32 v164, v164
    s_nop 0
    v_mul_f32 v163, v161, v164
    s_nop 1
    v_add_f32_dpp v163, v163, v163 quad_perm:[1,0,3,2] row_mask:0xf bank_mask:0xf
    s_nop 1
    v_add_f32_dpp v163, v163, v163 quad_perm:[2,3,0,1] row_mask:0xf bank_mask:0xf
    v_rcp_f32 v163, v163
    v_sub_f32 v164, v152, v162
    v_mul_f32 v164, s58, v164
    v_exp_f32 v164, v164
    v_mov_b32 v165, 1
    v_mul_f32 v164, v164, v163
    v_lshrrev_b32 v8, 1, v8
    ds_write_b64 v8, v[164:165] offset:1120
    s_barrier
    ds_read_b128 v[16:19], v5 offset:3072
    ds_read_b128 v[20:23], v5 offset:3584
    ds_read_b128 v[24:27], v5 offset:4096
    ds_read_b128 v[28:31], v5 offset:4608
    s_waitcnt lgkmcnt(2)
    v_add_f32 v16, v16, v20
    v_add_f32 v17, v17, v21
    v_add_f32 v18, v18, v22
    v_add_f32 v19, v19, v23
    s_waitcnt lgkmcnt(0)
    v_add_f32 v24, v24, v28
    v_add_f32 v25, v25, v29
    v_add_f32 v26, v26, v30
    v_add_f32 v27, v27, v31
    v_add_f32 v16, v16, v24
    v_add_f32 v17, v17, v25
    v_add_f32 v18, v18, v26
    v_add_f32 v19, v19, v27
    v_add_u32 v16, 0x100, v16
    v_add_u32 v17, 0x100, v17
    v_add_u32 v18, 0x100, v18
    v_add_u32 v19, 0x100, v19
    v_bfi_b32 v16, s37, v246, v16
    v_bfi_b32 v17, s37, v247, v17
    v_bfi_b32 v18, s37, v248, v18
    v_bfi_b32 v19, s37, v249, v19
    s_mov_b32 exec_hi, 0
    buffer_store_dwordx4 v[16:19], v5, s[44:47], s75 offen sc1
    s_mov_b64 exec, -1
    s_branch L_fin
L_h_idle0:
    s_cmp_lg_u32 s3, 3
    s_cbranch_scc1 L_h_noinit
    v_lshlrev_b32 v9, 3, v1
    v_mov_b32 v10, 0
    v_mov_b32 v11, 0
    ds_write_b64 v9, v[10:11] offset:1024
    s_waitcnt lgkmcnt(0)
L_h_noinit:
    s_barrier
    s_cmp_lg_u32 s3, 2
    s_cbranch_scc1 L_h_b
    s_mov_b32 s52, s22
    s_mov_b32 s53, s23
    s_movk_i32 s54, 1280
    v_and_b32 v9, 31, v1
    v_lshlrev_b32 v9, 3, v9
    v_lshrrev_b32 v10, 5, v1
    v_mul_u32_u24 v11, 1280, v10
    v_add_u32 v11, v11, v9
    buffer_load_dwordx2 v[200:201], v11, s[48:51], 0 offen offset:0
    buffer_load_dwordx2 v[210:211], v9, s[52:55], 0 offen offset:0
    buffer_load_dwordx2 v[202:203], v11, s[48:51], 0 offen offset:256
    buffer_load_dwordx2 v[212:213], v9, s[52:55], 0 offen offset:256
    buffer_load_dwordx2 v[204:205], v11, s[48:51], 0 offen offset:512
    buffer_load_dwordx2 v[214:215], v9, s[52:55], 0 offen offset:512
    buffer_load_dwordx2 v[206:207], v11, s[48:51], 0 offen offset:768
    buffer_load_dwordx2 v[216:217], v9, s[52:55], 0 offen offset:768
    buffer_load_dwordx2 v[208:209], v11, s[48:51], 0 offen offset:1024
    buffer_load_dwordx2 v[218:219], v9, s[52:55], 0 offen offset:1024
    v_mov_b32 v12, 0
    s_waitcnt vmcnt(0)
    v_lshlrev_b32 v220, 16, v200
    v_lshlrev_b32 v221, 16, v210
    v_and_b32 v222, 0xffff0000, v200
    v_and_b32 v223, 0xffff0000, v210
    v_mul_f32 v220, v220, v221
    v_mul_f32 v222, v222, v223
    v_cvt_pk_bf16_f32 v224, v220, v222
    v_lshlrev_b32 v220, 16, v224
    v_and_b32 v222, 0xffff0000, v224
    v_add_f32 v12, v12, v220
    v_add_f32 v12, v12, v222
    v_lshlrev_b32 v220, 16, v201
    v_lshlrev_b32 v221, 16, v211
    v_and_b32 v222, 0xffff0000, v201
    v_and_b32 v223, 0xffff0000, v211
    v_mul_f32 v220, v220, v221
    v_mul_f32 v222, v222, v223
    v_cvt_pk_bf16_f32 v224, v220, v222
    v_lshlrev_b32 v220, 16, v224
    v_and_b32 v222, 0xffff0000, v224
    v_add_f32 v12, v12, v220
    v_add_f32 v12, v12, v222
    v_lshlrev_b32 v220, 16, v202
    v_lshlrev_b32 v221, 16, v212
    v_and_b32 v222, 0xffff0000, v202
    v_and_b32 v223, 0xffff0000, v212
    v_mul_f32 v220, v220, v221
    v_mul_f32 v222, v222, v223
    v_cvt_pk_bf16_f32 v224, v220, v222
    v_lshlrev_b32 v220, 16, v224
    v_and_b32 v222, 0xffff0000, v224
    v_add_f32 v12, v12, v220
    v_add_f32 v12, v12, v222
    v_lshlrev_b32 v220, 16, v203
    v_lshlrev_b32 v221, 16, v213
    v_and_b32 v222, 0xffff0000, v203
    v_and_b32 v223, 0xffff0000, v213
    v_mul_f32 v220, v220, v221
    v_mul_f32 v222, v222, v223
    v_cvt_pk_bf16_f32 v224, v220, v222
    v_lshlrev_b32 v220, 16, v224
    v_and_b32 v222, 0xffff0000, v224
    v_add_f32 v12, v12, v220
    v_add_f32 v12, v12, v222
    v_lshlrev_b32 v220, 16, v204
    v_lshlrev_b32 v221, 16, v214
    v_and_b32 v222, 0xffff0000, v204
    v_and_b32 v223, 0xffff0000, v214
    v_mul_f32 v220, v220, v221
    v_mul_f32 v222, v222, v223
    v_cvt_pk_bf16_f32 v224, v220, v222
    v_lshlrev_b32 v220, 16, v224
    v_and_b32 v222, 0xffff0000, v224
    v_add_f32 v12, v12, v220
    v_add_f32 v12, v12, v222
    v_lshlrev_b32 v220, 16, v205
    v_lshlrev_b32 v221, 16, v215
    v_and_b32 v222, 0xffff0000, v205
    v_and_b32 v223, 0xffff0000, v215
    v_mul_f32 v220, v220, v221
    v_mul_f32 v222, v222, v223
    v_cvt_pk_bf16_f32 v224, v220, v222
    v_lshlrev_b32 v220, 16, v224
    v_and_b32 v222, 0xffff0000, v224
    v_add_f32 v12, v12, v220
    v_add_f32 v12, v12, v222
    v_lshlrev_b32 v220, 16, v206
    v_lshlrev_b32 v221, 16, v216
    v_and_b32 v222, 0xffff0000, v206
    v_and_b32 v223, 0xffff0000, v216
    v_mul_f32 v220, v220, v221
    v_mul_f32 v222, v222, v223
    v_cvt_pk_bf16_f32 v224, v220, v222
    v_lshlrev_b32 v220, 16, v224
    v_and_b32 v222, 0xffff0000, v224
    v_add_f32 v12, v12, v220
    v_add_f32 v12, v12, v222
    v_lshlrev_b32 v220, 16, v207
    v_lshlrev_b32 v221, 16, v217
    v_and_b32 v222, 0xffff0000, v207
    v_and_b32 v223, 0xffff0000, v217
    v_mul_f32 v220, v220, v221
    v_mul_f32 v222, v222, v223
    v_cvt_pk_bf16_f32 v224, v220, v222
    v_lshlrev_b32 v220, 16, v224
    v_and_b32 v222, 0xffff0000, v224
    v_add_f32 v12, v12, v220
    v_add_f32 v12, v12, v222
    v_lshlrev_b32 v220, 16, v208
    v_lshlrev_b32 v221, 16, v218
    v_and_b32 v222, 0xffff0000, v208
    v_and_b32 v223, 0xffff0000, v218
    v_mul_f32 v220, v220, v221
    v_mul_f32 v222, v222, v223
    v_cvt_pk_bf16_f32 v224, v220, v222
    v_lshlrev_b32 v220, 16, v224
    v_and_b32 v222, 0xffff0000, v224
    v_add_f32 v12, v12, v220
    v_add_f32 v12, v12, v222
    v_lshlrev_b32 v220, 16, v209
    v_lshlrev_b32 v221, 16, v219
    v_and_b32 v222, 0xffff0000, v209
    v_and_b32 v223, 0xffff0000, v219
    v_mul_f32 v220, v220, v221
    v_mul_f32 v222, v222, v223
    v_cvt_pk_bf16_f32 v224, v220, v222
    v_lshlrev_b32 v220, 16, v224
    v_and_b32 v222, 0xffff0000, v224
    v_add_f32 v12, v12, v220
    v_add_f32 v12, v12, v222
    s_nop 1
    v_add_f32_dpp v12, v12, v12 quad_perm:[1,0,3,2] row_mask:0xf bank_mask:0xf
    s_nop 1
    v_add_f32_dpp v12, v12, v12 quad_perm:[2,3,0,1] row_mask:0xf bank_mask:0xf
    s_nop 1
    v_add_f32_dpp v12, v12, v12 row_ror:8 row_mask:0xf bank_mask:0xf
    s_nop 1
    v_add_f32_dpp v12, v12, v12 row_ror:4 row_mask:0xf bank_mask:0xf
    v_mov_b32 v220, v12
    s_nop 1
    v_permlane16_swap_b32 v12, v220
    v_add_f32 v12, v12, v220
    v_cvt_pk_bf16_f32 v12, v12, v12
    v_and_b32 v12, 0xffff0000, v12
    v_mul_f32 v12, 0xbfb8aa3b, v12
    v_exp_f32 v12, v12
    s_nop 0
    v_add_f32 v12, 1.0, v12
    v_rcp_f32 v12, v12
    s_nop 0
    v_cvt_pk_bf16_f32 v12, v12, v12
    v_and_b32 v12, 0xffff0000, v12
    v_lshlrev_b32 v10, 2, v10
    ds_write_b32 v10, v12 offset:1108
    v_mov_b32 v11, 1
    s_waitcnt lgkmcnt(0)
    ds_write_b32 v7, v11 offset:1104
L_h_b:
    s_nop 4
    s_sub_u32 s72, s3, 1
    s_lshr_b32 s73, s38, 1
    s_and_b32 s74, s38, 1
    s_lshl_b32 s56, s30, 2
    s_add_u32 s56, s56, s73
    s_mul_i32 s56, s56, 40960
    s_add_u32 s40, s12, s56
    s_addc_u32 s41, s13, 0
    s_mov_b32 s42, 40960
    s_lshr_b32 s70, s2, 4
    s_lshl_b32 s70, s70, 3
    s_add_u32 s70, s70, s34
    s_mul_i32 s56, s70, 20480
    s_add_u32 s52, s20, s56
    s_addc_u32 s53, s21, 0
    s_cmp_lt_u32 s70, 108
    s_cselect_b32 s54, 20480, 0
    s_cselect_b32 s52, s52, s20
    s_cselect_b32 s53, s53, s21
    s_mul_i32 s56, s74, 640
    s_lshl_b32 s58, s72, 8
    s_add_u32 s56, s56, s58
    s_add_u32 s58, s56, 5120
    s_cmp_eq_u32 s72, 2
    s_cselect_b32 s80, 0x00ff00ff, -1
    s_mov_b32 s81, s80
    v_mul_u32_u24 v8, 10240, v3
    v_lshl_add_u32 v5, v2, 4, v8
    v_mul_u32_u24 v8, 5120, v3
    v_lshl_add_u32 v6, v2, 4, v8
    s_mov_b64 exec, s[80:81]
    buffer_load_dwordx4 v[16:19], v5, s[40:43], s56 offen offset:0 nt
    buffer_load_dwordx4 v[20:23], v5, s[40:43], s56 offen offset:1280 nt
    buffer_load_dwordx4 v[24:27], v5, s[40:43], s56 offen offset:2560 nt
    buffer_load_dwordx4 v[28:31], v5, s[40:43], s56 offen offset:3840 nt
    buffer_load_dwordx4 v[32:35], v5, s[40:43], s58 offen offset:0 nt
    buffer_load_dwordx4 v[36:39], v5, s[40:43], s58 offen offset:1280 nt
    buffer_load_dwordx4 v[40:43], v5, s[40:43], s58 offen offset:2560 nt
    buffer_load_dwordx4 v[44:47], v5, s[40:43], s58 offen offset:3840 nt
    buffer_load_dwordx4 v[48:51], v6, s[52:55], s56 offen offset:0 nt
    buffer_load_dwordx4 v[52:55], v6, s[52:55], s56 offen offset:1280 nt
    buffer_load_dwordx4 v[56:59], v6, s[52:55], s56 offen offset:2560 nt
    buffer_load_dwordx4 v[60:63], v6, s[52:55], s56 offen offset:3840 nt
    s_mov_b64 exec, -1
    s_mov_b32 s57, 960000
L_pt:
    s_nop 4
    ds_read_b64 v[10:11], v7 offset:1088
    s_waitcnt lgkmcnt(0)
    v_cmp_ne_u32 vcc, 1, v10
    s_cbranch_vccz L_pt_ok
    s_sleep 2
    s_sub_u32 s57, s57, 1
    s_cbranch_scc0 L_pt
L_pt_ok:
    v_mov_b32 v249, 0x9e3779b1
    v_mov_b32 v246, v11
    v_mul_lo_u32 v249, v249, v11
    v_lshrrev_b32 v247, 9, v249
    v_lshrrev_b32 v248, 18, v249
    v_lshrrev_b32 v249, 23, v249
    v_lshrrev_b32 v9, 5, v1
    v_lshlrev_b32 v9, 2, v9
    s_mov_b32 s57, 960000
L_pg:
    s_nop 4
    ds_read_b32 v10, v7 offset:1104
    ds_read_b32 v112, v9 offset:1108
    s_waitcnt lgkmcnt(0)
    v_cmp_ne_u32 vcc, 1, v10
    s_cbranch_vccz L_pg_ok
    s_sleep 2
    s_sub_u32 s57, s57, 1
    s_cbranch_scc0 L_pg
L_pg_ok:
    v_sub_f32 v113, 1.0, v112
    v_cvt_pk_bf16_f32 v113, v113, v113
    v_and_b32 v113, 0xffff0000, v113
    s_waitcnt vmcnt(0)
    v_perm_b32 v64, v20, v16, s35
    v_perm_b32 v65, v28, v24, s35
    v_perm_b32 v66, v36, v32, s35
    v_perm_b32 v67, v44, v40, s35
    v_perm_b32 v96, v52, v48, s35
    v_perm_b32 v97, v60, v56, s35
    v_perm_b32 v68, v20, v16, s36
    v_perm_b32 v69, v28, v24, s36
    v_perm_b32 v70, v36, v32, s36
    v_perm_b32 v71, v44, v40, s36
    v_perm_b32 v98, v52, v48, s36
    v_perm_b32 v99, v60, v56, s36
    v_perm_b32 v72, v21, v17, s35
    v_perm_b32 v73, v29, v25, s35
    v_perm_b32 v74, v37, v33, s35
    v_perm_b32 v75, v45, v41, s35
    v_perm_b32 v100, v53, v49, s35
    v_perm_b32 v101, v61, v57, s35
    v_perm_b32 v76, v21, v17, s36
    v_perm_b32 v77, v29, v25, s36
    v_perm_b32 v78, v37, v33, s36
    v_perm_b32 v79, v45, v41, s36
    v_perm_b32 v102, v53, v49, s36
    v_perm_b32 v103, v61, v57, s36
    v_perm_b32 v80, v22, v18, s35
    v_perm_b32 v81, v30, v26, s35
    v_perm_b32 v82, v38, v34, s35
    v_perm_b32 v83, v46, v42, s35
    v_perm_b32 v104, v54, v50, s35
    v_perm_b32 v105, v62, v58, s35
    v_perm_b32 v84, v22, v18, s36
    v_perm_b32 v85, v30, v26, s36
    v_perm_b32 v86, v38, v34, s36
    v_perm_b32 v87, v46, v42, s36
    v_perm_b32 v106, v54, v50, s36
    v_perm_b32 v107, v62, v58, s36
    v_perm_b32 v88, v23, v19, s35
    v_perm_b32 v89, v31, v27, s35
    v_perm_b32 v90, v39, v35, s35
    v_perm_b32 v91, v47, v43, s35
    v_perm_b32 v108, v55, v51, s35
    v_perm_b32 v109, v63, v59, s35
    v_perm_b32 v92, v23, v19, s36
    v_perm_b32 v93, v31, v27, s36
    v_perm_b32 v94, v39, v35, s36
    v_perm_b32 v95, v47, v43, s36
    v_perm_b32 v110, v55, v51, s36
    v_perm_b32 v111, v63, v59, s36
    v_mov_b32 v164, 0
    v_mov_b32 v165, 0
    v_mov_b32 v166, 0
    v_mov_b32 v167, 0
    v_and_b32 v10, 4, v2
    v_cmp_eq_u32 s[68:69], 0, v10
    s_cmp_ge_u32 s70, 108
    s_cbranch_scc1 L_h_nof2
    v_and_b32 v9, 7, v2
    v_lshlrev_b32 v9, 9, v9
    v_lshrrev_b32 v10, 3, v2
    v_lshl_add_u32 v9, v10, 8, v9
    v_lshl_add_u32 v9, v3, 4, v9
    s_lshr_b32 s56, s70, 2
    s_lshl_b32 s56, s56, 12
    s_and_b32 s58, s70, 3
    s_lshl_b32 s58, s58, 6
    s_add_u32 s56, s56, s58
    s_add_u32 s56, s56, 393216
    s_mov_b32 s57, 60000
L_pf:
    s_nop 4
    buffer_load_dwordx4 v[116:119], v9, s[44:47], s56 offen offset:0 sc1
    s_mov_b64 exec, -1
    s_waitcnt vmcnt(0)
    v_xor_b32 v10, v116, v246
    v_bitop3_b32 v10, v117, v247, v10 bitop3:0xbe
    v_bitop3_b32 v10, v118, v248, v10 bitop3:0xbe
    v_bitop3_b32 v10, v119, v249, v10 bitop3:0xbe
    v_and_b32 v10, 0x1ff, v10
    v_cmp_ne_u32 vcc, 0, v10
    s_sub_u32 s57, s57, 1
    s_cbranch_scc1 L_pf_ok
    s_cbranch_vccz L_pf_ok
    s_sleep 4
    s_mov_b64 exec, vcc
    s_branch L_pf
L_pf_ok:
    v_and_b32 v116, 0xfffffe00, v116
    v_and_b32 v117, 0xfffffe00, v117
    v_and_b32 v118, 0xfffffe00, v118
    v_and_b32 v119, 0xfffffe00, v119
    v_add_f32_dpp v116, v116, v116 quad_perm:[1,0,3,2] row_mask:0xf bank_mask:0xf
    v_add_f32_dpp v117, v117, v117 quad_perm:[1,0,3,2] row_mask:0xf bank_mask:0xf
    v_add_f32_dpp v118, v118, v118 quad_perm:[1,0,3,2] row_mask:0xf bank_mask:0xf
    v_add_f32_dpp v119, v119, v119 quad_perm:[1,0,3,2] row_mask:0xf bank_mask:0xf
    v_add_f32_dpp v116, v116, v116 quad_perm:[2,3,0,1] row_mask:0xf bank_mask:0xf
    v_add_f32_dpp v117, v117, v117 quad_perm:[2,3,0,1] row_mask:0xf bank_mask:0xf
    v_add_f32_dpp v118, v118, v118 quad_perm:[2,3,0,1] row_mask:0xf bank_mask:0xf
    v_add_f32_dpp v119, v119, v119 quad_perm:[2,3,0,1] row_mask:0xf bank_mask:0xf
    v_cvt_pk_bf16_f32 v120, v116, v117
    v_lshlrev_b32 v116, 16, v120
    v_and_b32 v117, 0xffff0000, v120
    v_cvt_pk_bf16_f32 v121, v118, v119
    v_lshlrev_b32 v118, 16, v121
    v_and_b32 v119, 0xffff0000, v121
    s_mov_b32 s56, 0x3d372713
    s_mov_b32 s57, 0xc0135761
    v_mov_b32_dpp v124, v116 row_shl:4 row_mask:0xf bank_mask:0xf bound_ctrl:0
    v_mov_b32_dpp v125, v117 row_shl:4 row_mask:0xf bank_mask:0xf bound_ctrl:0
    v_mov_b32_dpp v126, v118 row_shl:4 row_mask:0xf bank_mask:0xf bound_ctrl:0
    v_mov_b32_dpp v127, v119 row_shl:4 row_mask:0xf bank_mask:0xf bound_ctrl:0
    v_mul_f32 v120, v116, v116
    v_mul_f32 v121, v117, v117
    v_mul_f32 v122, v118, v118
    v_mul_f32 v123, v119, v119
    v_mul_f32 v120, v120, v116
    v_mul_f32 v121, v121, v117
    v_mul_f32 v122, v122, v118
    v_mul_f32 v123, v123, v119
    v_fma_f32 v120, v120, s56, v116
    v_fma_f32 v121, v121, s56, v117
    v_fma_f32 v122, v122, s56, v118
    v_fma_f32 v123, v123, s56, v119
    v_mul_f32 v120, s57, v120
    v_mul_f32 v121, s57, v121
    v_mul_f32 v122, s57, v122
    v_mul_f32 v123, s57, v123
    v_exp_f32 v120, v120
    v_exp_f32 v121, v121
    v_exp_f32 v122, v122
    v_exp_f32 v123, v123
    v_add_f32 v120, 1.0, v120
    v_add_f32 v121, 1.0, v121
    v_add_f32 v122, 1.0, v122
    v_add_f32 v123, 1.0, v123
    v_rcp_f32 v120, v120
    v_rcp_f32 v121, v121
    v_rcp_f32 v122, v122
    v_rcp_f32 v123, v123
    v_mul_f32 v116, v116, v120
    v_mul_f32 v117, v117, v121
    v_mul_f32 v118, v118, v122
    v_mul_f32 v119, v119, v123
    v_cvt_pk_bf16_f32 v120, v116, v117
    v_lshlrev_b32 v116, 16, v120
    v_and_b32 v117, 0xffff0000, v120
    v_cvt_pk_bf16_f32 v121, v118, v119
    v_lshlrev_b32 v118, 16, v121
    v_and_b32 v119, 0xffff0000, v121
    v_mul_f32 v116, v116, v124
    v_mul_f32 v117, v117, v125
    v_mul_f32 v118, v118, v126
    v_mul_f32 v119, v119, v127
    v_cvt_pk_bf16_f32 v120, v116, v117
    v_cvt_pk_bf16_f32 v121, v118, v119
    v_mov_b32 v124, 0
    v_mov_b32 v125, 0
    v_cndmask_b32 v122, 0, v120, s[68:69]
    v_cndmask_b32 v123, 0, v121, s[68:69]
    v_mov_b32_dpp v124, v120 row_shr:4 row_mask:0xf bank_mask:0xa
    v_mov_b32_dpp v125, v121 row_shr:4 row_mask:0xf bank_mask:0xa
    v_mfma_f32_16x16x16_bf16 v[132:135], v[122:123], v[96:97], 0
    v_mfma_f32_16x16x16_bf16 v[136:139], v[122:123], v[98:99], 0
    v_mfma_f32_16x16x16_bf16 v[140:143], v[122:123], v[100:101], 0
    v_mfma_f32_16x16x16_bf16 v[144:147], v[122:123], v[102:103], 0
    v_mfma_f32_16x16x16_bf16 v[132:135], v[124:125], v[104:105], v[132:135]
    v_mfma_f32_16x16x16_bf16 v[136:139], v[124:125], v[106:107], v[136:139]
    v_mfma_f32_16x16x16_bf16 v[140:143], v[124:125], v[108:109], v[140:143]
    v_mfma_f32_16x16x16_bf16 v[144:147], v[124:125], v[110:111], v[144:147]
    s_nop 4
    v_mul_f32 v164, v132, v113
    v_mul_f32 v165, v136, v113
    v_mul_f32 v166, v140, v113
    v_mul_f32 v167, v144, v113
L_h_nof2:
    s_nop 4
    v_lshrrev_b32 v200, 3, v1
    v_mul_u32_u24 v200, 2560, v200
    v_and_b32 v201, 7, v1
    v_lshl_add_u32 v200, v201, 4, v200
    s_cmp_ge_u32 s2, 20
    s_cselect_b32 s76, 325120, 0
    s_lshl_b32 s56, s2, 7
    s_add_u32 s76, s76, s56
    s_mul_i32 s56, s77, 40960
    s_add_u32 s76, s76, s56
    s_add_u32 s76, s76, 2097152
    s_add_u32 s79, s76, 20480
    s_lshl_b32 s56, s77, 7
    v_lshl_add_u32 v201, v201, 4, s56
    v_lshrrev_b32 v202, 4, v1
    v_lshl_add_u32 v201, v202, 2, v201
    v_lshrrev_b32 v8, 3, v2
    v_lshlrev_b32 v8, 16, v8
    v_and_b32 v9, 3, v2
    v_lshl_add_u32 v8, v9, 9, v8
    v_lshl_add_u32 v8, v3, 5, v8
    v_and_b32 v9, 4, v2
    v_lshl_add_u32 v168, v9, 2, v8
    s_lshl_b32 s56, s30, 11
    s_lshl_b32 s75, s73, 7
    s_add_u32 s75, s75, s56
    s_add_u32 s75, s75, 1048576
    s_lshl_b32 s56, s74, 7
    s_lshl_b32 s58, s34, 4
    s_add_u32 s56, s56, s58
    s_lshr_b32 s58, s2, 6
    s_lshl_b32 s58, s58, 2
    s_add_u32 s56, s56, s58
    s_add_u32 s56, s56, s73
    s_mul_i32 s56, s56, 2560
    s_lshl_b32 s58, s72, 10
    s_add_u32 s56, s56, s58
    s_add_u32 s74, s56, 2097152
    s_cmp_eq_u32 s72, 2
    s_cselect_b32 s58, 7, 8
    v_lshlrev_b32 v8, s58, v3
    v_lshl_add_u32 v169, v2, 4, v8
    v_mov_b32 v170, 0
    v_mov_b32 v30, 0
    v_mov_b32 v31, 0
    v_mov_b32 v32, 0
    v_mov_b32 v33, 0
    s_barrier
    s_sleep 6
    s_mov_b32 s57, 60000
    buffer_load_dwordx4 v[16:19], v168, s[44:47], s75 offen sc1
L_pr:
    s_nop 4
    s_sleep 3
    buffer_load_dwordx4 v[16:19], v168, s[44:47], s75 offen sc1
    s_mov_b64 exec, -1
    s_waitcnt vmcnt(1)
    v_xor_b32 v10, v16, v246
    v_bitop3_b32 v10, v17, v247, v10 bitop3:0xbe
    v_bitop3_b32 v10, v18, v248, v10 bitop3:0xbe
    v_bitop3_b32 v10, v19, v249, v10 bitop3:0xbe
    v_and_b32 v10, 0x1ff, v10
    v_cmp_ne_u32 vcc, 0, v10
    s_sub_u32 s57, s57, 1
    s_cbranch_scc1 L_pr_ok
    s_and_b64 exec, vcc, exec
    s_cbranch_scc1 L_pr
    s_mov_b64 exec, -1
L_pr_ok:
    v_and_b32 v20, 0xfffffe00, v16
    v_and_b32 v21, 0xfffffe00, v17
    v_and_b32 v22, 0xfffffe00, v18
    v_and_b32 v23, 0xfffffe00, v19
    v_add_f32_dpp v20, v20, v20 quad_perm:[1,0,3,2] row_mask:0xf bank_mask:0xf
    v_add_f32_dpp v21, v21, v21 quad_perm:[1,0,3,2] row_mask:0xf bank_mask:0xf
    v_add_f32_dpp v22, v22, v22 quad_perm:[1,0,3,2] row_mask:0xf bank_mask:0xf
    v_add_f32_dpp v23, v23, v23 quad_perm:[1,0,3,2] row_mask:0xf bank_mask:0xf
    v_add_f32_dpp v20, v20, v20 quad_perm:[2,3,0,1] row_mask:0xf bank_mask:0xf
    v_add_f32_dpp v21, v21, v21 quad_perm:[2,3,0,1] row_mask:0xf bank_mask:0xf
    v_add_f32_dpp v22, v22, v22 quad_perm:[2,3,0,1] row_mask:0xf bank_mask:0xf
    v_add_f32_dpp v23, v23, v23 quad_perm:[2,3,0,1] row_mask:0xf bank_mask:0xf
    v_cvt_pk_bf16_f32 v24, v20, v21
    v_cvt_pk_bf16_f32 v25, v22, v23
    v_cndmask_b32 v28, 0, v24, s[68:69]
    v_cndmask_b32 v29, 0, v25, s[68:69]
    v_mov_b32_dpp v30, v24 row_shl:4 row_mask:0xf bank_mask:0x5
    v_mov_b32_dpp v31, v25 row_shl:4 row_mask:0xf bank_mask:0x5
    v_mov_b32_dpp v32, v24 row_shr:4 row_mask:0xf bank_mask:0xa
    v_mov_b32_dpp v33, v25 row_shr:4 row_mask:0xf bank_mask:0xa
    v_cndmask_b32 v34, v24, 0, s[68:69]
    v_cndmask_b32 v35, v25, 0, s[68:69]
    v_mfma_f32_16x16x32_bf16 v[132:135], v[28:31], v[64:67], 0
    v_mfma_f32_16x16x32_bf16 v[136:139], v[28:31], v[68:71], 0
    v_mfma_f32_16x16x32_bf16 v[140:143], v[28:31], v[72:75], 0
    v_mfma_f32_16x16x32_bf16 v[144:147], v[28:31], v[76:79], 0
    v_mfma_f32_16x16x32_bf16 v[132:135], v[32:35], v[80:83], v[132:135]
    v_mfma_f32_16x16x32_bf16 v[136:139], v[32:35], v[84:87], v[136:139]
    v_mfma_f32_16x16x32_bf16 v[140:143], v[32:35], v[88:91], v[140:143]
    v_mfma_f32_16x16x32_bf16 v[144:147], v[32:35], v[92:95], v[144:147]
    s_nop 4
    v_fma_f32 v8, v132, v112, v164
    v_fma_f32 v9, v136, v112, v165
    v_fma_f32 v10, v140, v112, v166
    v_fma_f32 v11, v144, v112, v167
    v_add_u32 v8, 0x100, v8
    v_add_u32 v9, 0x100, v9
    v_add_u32 v10, 0x100, v10
    v_add_u32 v11, 0x100, v11
    v_bfi_b32 v8, s37, v246, v8
    v_bfi_b32 v9, s37, v247, v9
    v_bfi_b32 v10, s37, v248, v10
    v_bfi_b32 v11, s37, v249, v11
    s_mov_b64 exec, s[80:81]
    buffer_store_dwordx4 v[8:11], v169, s[44:47], s74 offen sc1
    s_mov_b64 exec, -1
L_fin:
    s_cmp_ge_u32 s2, 40
    s_cbranch_scc1 L_done
    s_mov_b32 s57, 60000
    buffer_load_dwordx4 v[204:207], v200, s[44:47], s76 offen sc1
    buffer_load_dwordx4 v[208:211], v200, s[44:47], s79 offen sc1
    s_mov_b32 s52, s24
    s_mov_b32 s53, s25
    s_movk_i32 s54, 2560
    s_waitcnt vmcnt(0)
    s_branch L_y_c
L_y1:
    s_sleep 6
    s_mov_b64 exec, 0xff
    buffer_load_dwordx4 v[204:207], v200, s[44:47], s76 offen sc1
    s_waitcnt vmcnt(0)
    v_xor_b32 v236, v204, v246
    v_bitop3_b32 v236, v205, v247, v236 bitop3:0xbe
    v_bitop3_b32 v236, v206, v248, v236 bitop3:0xbe
    v_bitop3_b32 v236, v207, v249, v236 bitop3:0xbe
    v_and_b32 v236, 0x1ff, v236
    v_cmp_ne_u32 vcc, 0, v236
    s_sub_u32 s57, s57, 1
    s_cbranch_scc1 L_y2
    s_cbranch_vccnz L_y1
L_y2:
    s_or_b64 exec, s[64:65], 1
    buffer_load_dwordx4 v[204:207], v200, s[44:47], s76 offen sc1
    s_or_b64 exec, s[66:67], 1
    buffer_load_dwordx4 v[208:211], v200, s[44:47], s79 offen sc1
    s_mov_b64 exec, -1
    s_sleep 4
L_y2l:
    s_or_b64 exec, s[64:65], 1
    buffer_load_dwordx4 v[204:207], v200, s[44:47], s76 offen sc1
    s_or_b64 exec, s[66:67], 1
    buffer_load_dwordx4 v[208:211], v200, s[44:47], s79 offen sc1
    s_mov_b64 exec, -1
    s_waitcnt vmcnt(2)
    v_xor_b32 v236, v204, v246
    v_bitop3_b32 v236, v205, v247, v236 bitop3:0xbe
    v_bitop3_b32 v236, v206, v248, v236 bitop3:0xbe
    v_bitop3_b32 v236, v207, v249, v236 bitop3:0xbe
    v_and_b32 v236, 0x1ff, v236
    v_xor_b32 v237, v208, v246
    v_bitop3_b32 v237, v209, v247, v237 bitop3:0xbe
    v_bitop3_b32 v237, v210, v248, v237 bitop3:0xbe
    v_bitop3_b32 v237, v211, v249, v237 bitop3:0xbe
    v_and_b32 v237, 0x1ff, v237
    v_cmp_ne_u32 s[64:65], 0, v236
    v_cmp_ne_u32 s[66:67], 0, v237
    s_nop 0
    s_or_b64 s[58:59], s[64:65], s[66:67]
    s_cbranch_scc0 L_y_ok
    s_sleep 4
    s_sub_u32 s57, s57, 1
    s_cbranch_scc0 L_y2l
    s_branch L_y_ok
L_y_c:
    v_xor_b32 v236, v204, v246
    v_bitop3_b32 v236, v205, v247, v236 bitop3:0xbe
    v_bitop3_b32 v236, v206, v248, v236 bitop3:0xbe
    v_bitop3_b32 v236, v207, v249, v236 bitop3:0xbe
    v_and_b32 v236, 0x1ff, v236
    v_xor_b32 v237, v208, v246
    v_bitop3_b32 v237, v209, v247, v237 bitop3:0xbe
    v_bitop3_b32 v237, v210, v248, v237 bitop3:0xbe
    v_bitop3_b32 v237, v211, v249, v237 bitop3:0xbe
    v_and_b32 v237, 0x1ff, v237
    v_cmp_ne_u32 s[64:65], 0, v236
    v_cmp_ne_u32 s[66:67], 0, v237
    s_nop 0
    s_or_b64 s[58:59], s[64:65], s[66:67]
    s_cbranch_scc0 L_y_ok
    s_and_b32 s58, s64, 0xff
    s_cbranch_scc1 L_y1
    s_branch L_y2
L_y_ok:
    v_and_b32 v220, 0xfffffe00, v204
    v_and_b32 v221, 0xfffffe00, v205
    v_and_b32 v222, 0xfffffe00, v206
    v_and_b32 v223, 0xfffffe00, v207
    v_and_b32 v224, 0xfffffe00, v208
    v_and_b32 v225, 0xfffffe00, v209
    v_and_b32 v226, 0xfffffe00, v210
    v_and_b32 v227, 0xfffffe00, v211
    v_add_f32 v220, v220, v224
    v_add_f32 v221, v221, v225
    v_add_f32 v222, v222, v226
    v_add_f32 v223, v223, v227
    v_add_f32_dpp v220, v220, v220 row_ror:8 row_mask:0xf bank_mask:0xf
    v_add_f32_dpp v221, v221, v221 row_ror:8 row_mask:0xf bank_mask:0xf
    v_add_f32_dpp v222, v222, v222 row_ror:8 row_mask:0xf bank_mask:0xf
    v_add_f32_dpp v223, v223, v223 row_ror:8 row_mask:0xf bank_mask:0xf
    v_permlane16_swap_b32 v220, v221
    s_nop 0
    v_permlane16_swap_b32 v222, v223
    v_add_f32 v220, v220, v221
    v_add_f32 v222, v222, v223
    s_nop 1
    v_permlane32_swap_b32 v220, v222
    v_add_f32 v220, v220, v222
    ds_write_b32 v201, v220 offset:2048
    s_waitcnt lgkmcnt(0)
    s_barrier
    s_cmp_lg_u32 s77, 0
    s_cbranch_scc1 L_done
    ds_read_b32 v221, v201 offset:2176
    ds_read_b32 v222, v201 offset:2304
    ds_read_b32 v223, v201 offset:2432
    ds_read_b32 v224, v201 offset:2560
    ds_read_b32 v225, v201 offset:2688
    ds_read_b32 v226, v201 offset:2816
    ds_read_b32 v227, v201 offset:2944
    s_waitcnt lgkmcnt(0)
    v_add_f32 v220, v220, v221
    v_add_f32 v222, v222, v223
    v_add_f32 v224, v224, v225
    v_add_f32 v226, v226, v227
    v_add_f32 v220, v220, v222
    v_add_f32 v224, v224, v226
    v_add_f32 v220, v220, v224
    v_mov_b32 v221, v220
    s_nop 1
    v_permlane16_swap_b32 v220, v221
    v_cvt_pk_bf16_f32 v10, v220, v221
    s_mov_b32 exec_lo, 0xff
    s_mov_b32 exec_hi, 0xff
    buffer_store_dword v10, v170, s[52:55], s78 offen
    s_cmp_lg_u32 s2, 0
    s_cbranch_scc1 L_done
    s_mov_b64 exec, 1
    buffer_store_dword v246, v170, s[44:47], 0 offen offset:0 sc1
L_done:
    s_endpgm
.p2align 6
L_stream:
    s_sub_u32 s3, s3, 4
    s_lshl_b32 s56, s33, 2
    s_add_u32 s56, s56, s32
    s_lshl_b32 s56, s56, 19
    s_lshl_b32 s57, s3, 12
    v_lshlrev_b32 v4, 4, v1
    v_add_u32 v50, s57, v4
    s_mov_b32 s42, 0x80000
    s_waitcnt lgkmcnt(0)
    s_add_u32 s40, s6, s56
    s_addc_u32 s41, s7, 0
    s_add_u32 s48, s8, s56
    s_addc_u32 s49, s9, 0
    s_mov_b32 s58, 0
    s_barrier
    buffer_load_dwordx4 v[64:67], v50, s[40:43], s58 offen offset:0 nt
    buffer_load_dwordx4 v[68:71], v50, s[40:43], s58 offen offset:1024 nt
    buffer_load_dwordx4 v[72:75], v50, s[40:43], s58 offen offset:2048 nt
    buffer_load_dwordx4 v[76:79], v50, s[40:43], s58 offen offset:3072 nt
    s_mov_b32 s58, 16384
    buffer_load_dwordx4 v[80:83], v50, s[40:43], s58 offen offset:0 nt
    buffer_load_dwordx4 v[84:87], v50, s[40:43], s58 offen offset:1024 nt
    buffer_load_dwordx4 v[88:91], v50, s[40:43], s58 offen offset:2048 nt
    buffer_load_dwordx4 v[92:95], v50, s[40:43], s58 offen offset:3072 nt
    s_mov_b32 s58, 32768
    s_waitcnt vmcnt(6)
    buffer_load_dwordx4 v[96:99], v50, s[40:43], s58 offen offset:0 nt
    buffer_load_dwordx4 v[100:103], v50, s[40:43], s58 offen offset:1024 nt
    s_waitcnt vmcnt(6)
    buffer_load_dwordx4 v[104:107], v50, s[40:43], s58 offen offset:2048 nt
    buffer_load_dwordx4 v[108:111], v50, s[40:43], s58 offen offset:3072 nt
    s_mov_b32 s58, 49152
    s_waitcnt vmcnt(6)
    buffer_load_dwordx4 v[112:115], v50, s[40:43], s58 offen offset:0 nt
    buffer_load_dwordx4 v[116:119], v50, s[40:43], s58 offen offset:1024 nt
    s_waitcnt vmcnt(6)
    buffer_load_dwordx4 v[120:123], v50, s[40:43], s58 offen offset:2048 nt
    buffer_load_dwordx4 v[124:127], v50, s[40:43], s58 offen offset:3072 nt
    s_mov_b32 s58, 65536
    s_waitcnt vmcnt(6)
    buffer_load_dwordx4 v[128:131], v50, s[40:43], s58 offen offset:0 nt
    buffer_load_dwordx4 v[132:135], v50, s[40:43], s58 offen offset:1024 nt
    v_mov_b32 v4, 0
    v_mov_b32 v5, 1
    ds_write_b32 v4, v5 offset:1156
    s_waitcnt vmcnt(6)
    buffer_load_dwordx4 v[136:139], v50, s[40:43], s58 offen offset:2048 nt
    buffer_load_dwordx4 v[140:143], v50, s[40:43], s58 offen offset:3072 nt
    s_mov_b32 s58, 81920
    s_waitcnt vmcnt(6)
    buffer_load_dwordx4 v[144:147], v50, s[40:43], s58 offen offset:0 nt
    buffer_load_dwordx4 v[148:151], v50, s[40:43], s58 offen offset:1024 nt
    s_waitcnt vmcnt(6)
    buffer_load_dwordx4 v[152:155], v50, s[40:43], s58 offen offset:2048 nt
    buffer_load_dwordx4 v[156:159], v50, s[40:43], s58 offen offset:3072 nt
    s_mov_b32 s58, 98304
    s_waitcnt vmcnt(6)
    buffer_load_dwordx4 v[160:163], v50, s[40:43], s58 offen offset:0 nt
    buffer_load_dwordx4 v[164:167], v50, s[40:43], s58 offen offset:1024 nt
    s_waitcnt vmcnt(6)
    buffer_load_dwordx4 v[168:171], v50, s[40:43], s58 offen offset:2048 nt
    buffer_load_dwordx4 v[172:175], v50, s[40:43], s58 offen offset:3072 nt
    s_mov_b32 s58, 114688
    s_waitcnt vmcnt(6)
    buffer_load_dwordx4 v[176:179], v50, s[40:43], s58 offen offset:0 nt
    buffer_load_dwordx4 v[180:183], v50, s[40:43], s58 offen offset:1024 nt
    s_waitcnt vmcnt(6)
    buffer_load_dwordx4 v[184:187], v50, s[40:43], s58 offen offset:2048 nt
    buffer_load_dwordx4 v[188:191], v50, s[40:43], s58 offen offset:3072 nt
    s_mov_b32 s44, s28
    s_mov_b32 s45, s29
    v_and_b32 v4, 2, v0
    v_cmp_ne_u32 s[80:81], 0, v4
    v_and_b32 v4, 1, v0
    v_cmp_ne_u32 s[82:83], 0, v4
    v_mov_b32 v16, 0
    v_mov_b32 v17, 0
    v_mov_b32 v18, 0
    v_mov_b32 v19, 0
    v_mov_b32 v20, 0
    v_mov_b32 v21, 0
    v_mov_b32 v22, 0
    v_mov_b32 v23, 0
    v_lshlrev_b32 v40, 5, v2
    v_lshl_add_u32 v40, v3, 3, v40
    s_lshl_b32 s56, s3, 9
    v_add_u32 v40, s56, v40
    s_lshl_b32 s56, s3, 3
    v_mov_b32 v41, s56
    v_lshrrev_b32 v200, 3, v1
    v_mul_u32_u24 v200, 2560, v200
    v_and_b32 v201, 7, v1
    v_lshl_add_u32 v200, v201, 4, v200
    s_cmp_ge_u32 s2, 20
    s_cselect_b32 s76, 325120, 0
    s_lshl_b32 s56, s2, 7
    s_add_u32 s76, s76, s56
    s_mul_i32 s56, s77, 40960
    s_add_u32 s76, s76, s56
    s_add_u32 s76, s76, 2097152
    s_add_u32 s79, s76, 20480
    s_lshl_b32 s56, s77, 7
    v_lshl_add_u32 v201, v201, 4, s56
    v_lshrrev_b32 v202, 4, v1
    v_lshl_add_u32 v201, v202, 2, v201
    v_lshlrev_b32 v24, 4, v2
    v_mov_b32 v25, 0
    s_mov_b32 s57, 960000
L_ps:
    s_nop 4
    ds_read_b64 v[44:45], v25 offset:1088
    s_waitcnt lgkmcnt(0)
    v_cmp_ne_u32 vcc, 1, v44
    s_cbranch_vccz L_ps_ok
    s_sleep 1
    s_sub_u32 s57, s57, 1
    s_cbranch_scc0 L_ps
L_ps_ok:
    ds_read_b128 v[4:7], v24 offset:0
    v_mov_b32 v249, 0x9e3779b1
    v_mov_b32 v246, v45
    v_mul_lo_u32 v249, v249, v45
    v_lshrrev_b32 v247, 9, v249
    v_lshrrev_b32 v248, 18, v249
    v_lshrrev_b32 v249, 23, v249
    s_mov_b32 s59, 0
    s_mov_b32 s60, 131072
    s_waitcnt lgkmcnt(0)
.p2align 6
L_kloop:
    s_nop 4
    s_cmp_eq_u32 s59, 3
    s_cselect_b32 s40, s48, s40
    s_cselect_b32 s41, s49, s41
    s_cselect_b32 s60, 0, s60
    v_mov_b32 v8, v10
    v_mov_b32 v9, v11
    v_mov_b32 v10, v12
    v_mov_b32 v11, v13
    v_mov_b32 v12, v14
    v_mov_b32 v13, v15
    v_dot2_f32_bf16 v24, v64, v4, 0
    v_dot2_f32_bf16 v25, v68, v4, 0
    v_dot2_f32_bf16 v26, v72, v4, 0
    v_dot2_f32_bf16 v27, v76, v4, 0
    v_dot2c_f32_bf16 v24, v65, v5
    v_dot2c_f32_bf16 v25, v69, v5
    v_dot2c_f32_bf16 v26, v73, v5
    v_dot2c_f32_bf16 v27, v77, v5
    v_dot2c_f32_bf16 v24, v66, v6
    v_dot2c_f32_bf16 v25, v70, v6
    v_dot2c_f32_bf16 v26, v74, v6
    v_dot2c_f32_bf16 v27, v78, v6
    v_dot2c_f32_bf16 v24, v67, v7
    v_dot2c_f32_bf16 v25, v71, v7
    v_dot2c_f32_bf16 v26, v75, v7
    v_dot2c_f32_bf16 v27, v79, v7
    s_add_u32 s58, s60, 0
    s_waitcnt vmcnt(4)
    buffer_load_dwordx4 v[64:67], v50, s[40:43], s58 offen offset:0 nt
    buffer_load_dwordx4 v[68:71], v50, s[40:43], s58 offen offset:1024 nt
    v_add_f32_dpp v24, v24, v24 row_ror:8 row_mask:0xf bank_mask:0x3
    v_add_f32_dpp v26, v26, v26 row_ror:8 row_mask:0xf bank_mask:0x3
    s_nop 0
    v_add_f32_dpp v24, v25, v25 row_ror:8 row_mask:0xf bank_mask:0xc
    v_add_f32_dpp v26, v27, v27 row_ror:8 row_mask:0xf bank_mask:0xc
    s_nop 0
    v_add_f32_dpp v32, v24, v24 row_shl:4 row_mask:0xf bank_mask:0x5
    s_nop 1
    v_add_f32_dpp v32, v26, v26 row_shr:4 row_mask:0xf bank_mask:0xa
    s_waitcnt vmcnt(4)
    buffer_load_dwordx4 v[72:75], v50, s[40:43], s58 offen offset:2048 nt
    buffer_load_dwordx4 v[76:79], v50, s[40:43], s58 offen offset:3072 nt
    v_dot2_f32_bf16 v28, v80, v4, 0
    v_dot2_f32_bf16 v29, v84, v4, 0
    v_dot2_f32_bf16 v30, v88, v4, 0
    v_dot2_f32_bf16 v31, v92, v4, 0
    v_dot2c_f32_bf16 v28, v81, v5
    v_dot2c_f32_bf16 v29, v85, v5
    v_dot2c_f32_bf16 v30, v89, v5
    v_dot2c_f32_bf16 v31, v93, v5
    v_dot2c_f32_bf16 v28, v82, v6
    v_dot2c_f32_bf16 v29, v86, v6
    v_dot2c_f32_bf16 v30, v90, v6
    v_dot2c_f32_bf16 v31, v94, v6
    v_dot2c_f32_bf16 v28, v83, v7
    v_dot2c_f32_bf16 v29, v87, v7
    v_dot2c_f32_bf16 v30, v91, v7
    v_dot2c_f32_bf16 v31, v95, v7
    s_add_u32 s58, s60, 16384
    s_waitcnt vmcnt(4)
    buffer_load_dwordx4 v[80:83], v50, s[40:43], s58 offen offset:0 nt
    buffer_load_dwordx4 v[84:87], v50, s[40:43], s58 offen offset:1024 nt
    v_add_f32_dpp v28, v28, v28 row_ror:8 row_mask:0xf bank_mask:0x3
    v_add_f32_dpp v30, v30, v30 row_ror:8 row_mask:0xf bank_mask:0x3
    s_nop 0
    v_add_f32_dpp v28, v29, v29 row_ror:8 row_mask:0xf bank_mask:0xc
    v_add_f32_dpp v30, v31, v31 row_ror:8 row_mask:0xf bank_mask:0xc
    s_nop 0
    v_add_f32_dpp v33, v28, v28 row_shl:4 row_mask:0xf bank_mask:0x5
    s_nop 1
    v_add_f32_dpp v33, v30, v30 row_shr:4 row_mask:0xf bank_mask:0xa
    v_cndmask_b32 v34, v33, v32, s[80:81]
    v_cndmask_b32 v35, v32, v33, s[80:81]
    s_nop 1
    v_add_f32_dpp v36, v34, v35 quad_perm:[2,3,0,1] row_mask:0xf bank_mask:0xf
    s_waitcnt vmcnt(4)
    buffer_load_dwordx4 v[88:91], v50, s[40:43], s58 offen offset:2048 nt
    buffer_load_dwordx4 v[92:95], v50, s[40:43], s58 offen offset:3072 nt
    v_dot2_f32_bf16 v24, v96, v4, 0
    v_dot2_f32_bf16 v25, v100, v4, 0
    v_dot2_f32_bf16 v26, v104, v4, 0
    v_dot2_f32_bf16 v27, v108, v4, 0
    v_dot2c_f32_bf16 v24, v97, v5
    v_dot2c_f32_bf16 v25, v101, v5
    v_dot2c_f32_bf16 v26, v105, v5
    v_dot2c_f32_bf16 v27, v109, v5
    v_dot2c_f32_bf16 v24, v98, v6
    v_dot2c_f32_bf16 v25, v102, v6
    v_dot2c_f32_bf16 v26, v106, v6
    v_dot2c_f32_bf16 v27, v110, v6
    v_dot2c_f32_bf16 v24, v99, v7
    v_dot2c_f32_bf16 v25, v103, v7
    v_dot2c_f32_bf16 v26, v107, v7
    v_dot2c_f32_bf16 v27, v111, v7
    s_add_u32 s58, s60, 32768
    s_waitcnt vmcnt(4)
    buffer_load_dwordx4 v[96:99], v50, s[40:43], s58 offen offset:0 nt
    buffer_load_dwordx4 v[100:103], v50, s[40:43], s58 offen offset:1024 nt
    v_add_f32_dpp v24, v24, v24 row_ror:8 row_mask:0xf bank_mask:0x3
    v_add_f32_dpp v26, v26, v26 row_ror:8 row_mask:0xf bank_mask:0x3
    s_nop 0
    v_add_f32_dpp v24, v25, v25 row_ror:8 row_mask:0xf bank_mask:0xc
    v_add_f32_dpp v26, v27, v27 row_ror:8 row_mask:0xf bank_mask:0xc
    s_nop 0
    v_add_f32_dpp v32, v24, v24 row_shl:4 row_mask:0xf bank_mask:0x5
    s_nop 1
    v_add_f32_dpp v32, v26, v26 row_shr:4 row_mask:0xf bank_mask:0xa
    s_waitcnt vmcnt(4)
    buffer_load_dwordx4 v[104:107], v50, s[40:43], s58 offen offset:2048 nt
    buffer_load_dwordx4 v[108:111], v50, s[40:43], s58 offen offset:3072 nt
    v_dot2_f32_bf16 v28, v112, v4, 0
    v_dot2_f32_bf16 v29, v116, v4, 0
    v_dot2_f32_bf16 v30, v120, v4, 0
    v_dot2_f32_bf16 v31, v124, v4, 0
    v_dot2c_f32_bf16 v28, v113, v5
    v_dot2c_f32_bf16 v29, v117, v5
    v_dot2c_f32_bf16 v30, v121, v5
    v_dot2c_f32_bf16 v31, v125, v5
    v_dot2c_f32_bf16 v28, v114, v6
    v_dot2c_f32_bf16 v29, v118, v6
    v_dot2c_f32_bf16 v30, v122, v6
    v_dot2c_f32_bf16 v31, v126, v6
    v_dot2c_f32_bf16 v28, v115, v7
    v_dot2c_f32_bf16 v29, v119, v7
    v_dot2c_f32_bf16 v30, v123, v7
    v_dot2c_f32_bf16 v31, v127, v7
    s_add_u32 s58, s60, 49152
    s_waitcnt vmcnt(4)
    buffer_load_dwordx4 v[112:115], v50, s[40:43], s58 offen offset:0 nt
    buffer_load_dwordx4 v[116:119], v50, s[40:43], s58 offen offset:1024 nt
    v_add_f32_dpp v28, v28, v28 row_ror:8 row_mask:0xf bank_mask:0x3
    v_add_f32_dpp v30, v30, v30 row_ror:8 row_mask:0xf bank_mask:0x3
    s_nop 0
    v_add_f32_dpp v28, v29, v29 row_ror:8 row_mask:0xf bank_mask:0xc
    v_add_f32_dpp v30, v31, v31 row_ror:8 row_mask:0xf bank_mask:0xc
    s_nop 0
    v_add_f32_dpp v33, v28, v28 row_shl:4 row_mask:0xf bank_mask:0x5
    s_nop 1
    v_add_f32_dpp v33, v30, v30 row_shr:4 row_mask:0xf bank_mask:0xa
    v_cndmask_b32 v34, v33, v32, s[80:81]
    v_cndmask_b32 v35, v32, v33, s[80:81]
    s_nop 1
    v_add_f32_dpp v37, v34, v35 quad_perm:[2,3,0,1] row_mask:0xf bank_mask:0xf
    v_cndmask_b32 v34, v37, v36, s[82:83]
    v_cndmask_b32 v35, v36, v37, s[82:83]
    s_nop 1
    v_add_f32_dpp v14, v34, v35 quad_perm:[1,0,3,2] row_mask:0xf bank_mask:0xf
    s_waitcnt vmcnt(4)
    buffer_load_dwordx4 v[120:123], v50, s[40:43], s58 offen offset:2048 nt
    buffer_load_dwordx4 v[124:127], v50, s[40:43], s58 offen offset:3072 nt
    v_dot2_f32_bf16 v24, v128, v4, 0
    v_dot2_f32_bf16 v25, v132, v4, 0
    v_dot2_f32_bf16 v26, v136, v4, 0
    v_dot2_f32_bf16 v27, v140, v4, 0
    v_dot2c_f32_bf16 v24, v129, v5
    v_dot2c_f32_bf16 v25, v133, v5
    v_dot2c_f32_bf16 v26, v137, v5
    v_dot2c_f32_bf16 v27, v141, v5
    v_dot2c_f32_bf16 v24, v130, v6
    v_dot2c_f32_bf16 v25, v134, v6
    v_dot2c_f32_bf16 v26, v138, v6
    v_dot2c_f32_bf16 v27, v142, v6
    v_dot2c_f32_bf16 v24, v131, v7
    v_dot2c_f32_bf16 v25, v135, v7
    v_dot2c_f32_bf16 v26, v139, v7
    v_dot2c_f32_bf16 v27, v143, v7
    s_add_u32 s58, s60, 65536
    s_waitcnt vmcnt(4)
    buffer_load_dwordx4 v[128:131], v50, s[40:43], s58 offen offset:0 nt
    buffer_load_dwordx4 v[132:135], v50, s[40:43], s58 offen offset:1024 nt
    v_add_f32_dpp v24, v24, v24 row_ror:8 row_mask:0xf bank_mask:0x3
    v_add_f32_dpp v26, v26, v26 row_ror:8 row_mask:0xf bank_mask:0x3
    s_nop 0
    v_add_f32_dpp v24, v25, v25 row_ror:8 row_mask:0xf bank_mask:0xc
    v_add_f32_dpp v26, v27, v27 row_ror:8 row_mask:0xf bank_mask:0xc
    s_nop 0
    v_add_f32_dpp v32, v24, v24 row_shl:4 row_mask:0xf bank_mask:0x5
    s_nop 1
    v_add_f32_dpp v32, v26, v26 row_shr:4 row_mask:0xf bank_mask:0xa
    s_waitcnt vmcnt(4)
    buffer_load_dwordx4 v[136:139], v50, s[40:43], s58 offen offset:2048 nt
    buffer_load_dwordx4 v[140:143], v50, s[40:43], s58 offen offset:3072 nt
    v_dot2_f32_bf16 v28, v144, v4, 0
    v_dot2_f32_bf16 v29, v148, v4, 0
    v_dot2_f32_bf16 v30, v152, v4, 0
    v_dot2_f32_bf16 v31, v156, v4, 0
    v_dot2c_f32_bf16 v28, v145, v5
    v_dot2c_f32_bf16 v29, v149, v5
    v_dot2c_f32_bf16 v30, v153, v5
    v_dot2c_f32_bf16 v31, v157, v5
    v_dot2c_f32_bf16 v28, v146, v6
    v_dot2c_f32_bf16 v29, v150, v6
    v_dot2c_f32_bf16 v30, v154, v6
    v_dot2c_f32_bf16 v31, v158, v6
    v_dot2c_f32_bf16 v28, v147, v7
    v_dot2c_f32_bf16 v29, v151, v7
    v_dot2c_f32_bf16 v30, v155, v7
    v_dot2c_f32_bf16 v31, v159, v7
    s_add_u32 s58, s60, 81920
    s_waitcnt vmcnt(4)
    buffer_load_dwordx4 v[144:147], v50, s[40:43], s58 offen offset:0 nt
    buffer_load_dwordx4 v[148:151], v50, s[40:43], s58 offen offset:1024 nt
    v_add_f32_dpp v28, v28, v28 row_ror:8 row_mask:0xf bank_mask:0x3
    v_add_f32_dpp v30, v30, v30 row_ror:8 row_mask:0xf bank_mask:0x3
    s_nop 0
    v_add_f32_dpp v28, v29, v29 row_ror:8 row_mask:0xf bank_mask:0xc
    v_add_f32_dpp v30, v31, v31 row_ror:8 row_mask:0xf bank_mask:0xc
    s_nop 0
    v_add_f32_dpp v33, v28, v28 row_shl:4 row_mask:0xf bank_mask:0x5
    s_nop 1
    v_add_f32_dpp v33, v30, v30 row_shr:4 row_mask:0xf bank_mask:0xa
    v_cndmask_b32 v34, v33, v32, s[80:81]
    v_cndmask_b32 v35, v32, v33, s[80:81]
    s_nop 1
    v_add_f32_dpp v36, v34, v35 quad_perm:[2,3,0,1] row_mask:0xf bank_mask:0xf
    s_waitcnt vmcnt(4)
    buffer_load_dwordx4 v[152:155], v50, s[40:43], s58 offen offset:2048 nt
    buffer_load_dwordx4 v[156:159], v50, s[40:43], s58 offen offset:3072 nt
    v_dot2_f32_bf16 v24, v160, v4, 0
    v_dot2_f32_bf16 v25, v164, v4, 0
    v_dot2_f32_bf16 v26, v168, v4, 0
    v_dot2_f32_bf16 v27, v172, v4, 0
    v_dot2c_f32_bf16 v24, v161, v5
    v_dot2c_f32_bf16 v25, v165, v5
    v_dot2c_f32_bf16 v26, v169, v5
    v_dot2c_f32_bf16 v27, v173, v5
    v_dot2c_f32_bf16 v24, v162, v6
    v_dot2c_f32_bf16 v25, v166, v6
    v_dot2c_f32_bf16 v26, v170, v6
    v_dot2c_f32_bf16 v27, v174, v6
    v_dot2c_f32_bf16 v24, v163, v7
    v_dot2c_f32_bf16 v25, v167, v7
    v_dot2c_f32_bf16 v26, v171, v7
    v_dot2c_f32_bf16 v27, v175, v7
    s_add_u32 s58, s60, 98304
    s_waitcnt vmcnt(4)
    buffer_load_dwordx4 v[160:163], v50, s[40:43], s58 offen offset:0 nt
    buffer_load_dwordx4 v[164:167], v50, s[40:43], s58 offen offset:1024 nt
    v_add_f32_dpp v24, v24, v24 row_ror:8 row_mask:0xf bank_mask:0x3
    v_add_f32_dpp v26, v26, v26 row_ror:8 row_mask:0xf bank_mask:0x3
    s_nop 0
    v_add_f32_dpp v24, v25, v25 row_ror:8 row_mask:0xf bank_mask:0xc
    v_add_f32_dpp v26, v27, v27 row_ror:8 row_mask:0xf bank_mask:0xc
    s_nop 0
    v_add_f32_dpp v32, v24, v24 row_shl:4 row_mask:0xf bank_mask:0x5
    s_nop 1
    v_add_f32_dpp v32, v26, v26 row_shr:4 row_mask:0xf bank_mask:0xa
    s_waitcnt vmcnt(4)
    buffer_load_dwordx4 v[168:171], v50, s[40:43], s58 offen offset:2048 nt
    buffer_load_dwordx4 v[172:175], v50, s[40:43], s58 offen offset:3072 nt
    v_dot2_f32_bf16 v28, v176, v4, 0
    v_dot2_f32_bf16 v29, v180, v4, 0
    v_dot2_f32_bf16 v30, v184, v4, 0
    v_dot2_f32_bf16 v31, v188, v4, 0
    v_dot2c_f32_bf16 v28, v177, v5
    v_dot2c_f32_bf16 v29, v181, v5
    v_dot2c_f32_bf16 v30, v185, v5
    v_dot2c_f32_bf16 v31, v189, v5
    v_dot2c_f32_bf16 v28, v178, v6
    v_dot2c_f32_bf16 v29, v182, v6
    v_dot2c_f32_bf16 v30, v186, v6
    v_dot2c_f32_bf16 v31, v190, v6
    v_dot2c_f32_bf16 v28, v179, v7
    v_dot2c_f32_bf16 v29, v183, v7
    v_dot2c_f32_bf16 v30, v187, v7
    v_dot2c_f32_bf16 v31, v191, v7
    s_add_u32 s58, s60, 114688
    s_waitcnt vmcnt(4)
    buffer_load_dwordx4 v[176:179], v50, s[40:43], s58 offen offset:0 nt
    buffer_load_dwordx4 v[180:183], v50, s[40:43], s58 offen offset:1024 nt
    v_add_f32_dpp v28, v28, v28 row_ror:8 row_mask:0xf bank_mask:0x3
    v_add_f32_dpp v30, v30, v30 row_ror:8 row_mask:0xf bank_mask:0x3
    s_nop 0
    v_add_f32_dpp v28, v29, v29 row_ror:8 row_mask:0xf bank_mask:0xc
    v_add_f32_dpp v30, v31, v31 row_ror:8 row_mask:0xf bank_mask:0xc
    s_nop 0
    v_add_f32_dpp v33, v28, v28 row_shl:4 row_mask:0xf bank_mask:0x5
    s_nop 1
    v_add_f32_dpp v33, v30, v30 row_shr:4 row_mask:0xf bank_mask:0xa
    v_cndmask_b32 v34, v33, v32, s[80:81]
    v_cndmask_b32 v35, v32, v33, s[80:81]
    s_nop 1
    v_add_f32_dpp v37, v34, v35 quad_perm:[2,3,0,1] row_mask:0xf bank_mask:0xf
    v_cndmask_b32 v34, v37, v36, s[82:83]
    v_cndmask_b32 v35, v36, v37, s[82:83]
    s_nop 1
    v_add_f32_dpp v15, v34, v35 quad_perm:[1,0,3,2] row_mask:0xf bank_mask:0xf
    s_waitcnt vmcnt(4)
    buffer_load_dwordx4 v[184:187], v50, s[40:43], s58 offen offset:2048 nt
    buffer_load_dwordx4 v[188:191], v50, s[40:43], s58 offen offset:3072 nt
    s_add_u32 s60, s60, 131072
    s_add_u32 s59, s59, 1
    s_cmp_lt_u32 s59, 4
    s_cbranch_scc1 L_kloop
    s_mov_b32 s56, 0x3db504f3
    s_mov_b32 s57, 0x3fb8aa3b
    v_cvt_pk_bf16_f32 v24, v8, v9
    v_cvt_pk_bf16_f32 v26, v10, v11
    v_cvt_pk_bf16_f32 v28, v12, v13
    v_cvt_pk_bf16_f32 v30, v14, v15
    v_lshlrev_b32 v8, 16, v24
    v_and_b32 v9, 0xffff0000, v24
    v_lshlrev_b32 v10, 16, v26
    v_and_b32 v11, 0xffff0000, v26
    v_lshlrev_b32 v12, 16, v28
    v_and_b32 v13, 0xffff0000, v28
    v_lshlrev_b32 v14, 16, v30
    v_and_b32 v15, 0xffff0000, v30
    v_mul_f32 v8, s56, v8
    v_mul_f32 v9, s56, v9
    v_mul_f32 v10, s56, v10
    v_mul_f32 v11, s56, v11
    v_mul_f32 v12, s56, v12
    v_mul_f32 v13, s56, v13
    v_mul_f32 v14, s56, v14
    v_mul_f32 v15, s56, v15
    v_cvt_pk_bf16_f32 v24, v8, v9
    v_cvt_pk_bf16_f32 v26, v10, v11
    v_cvt_pk_bf16_f32 v28, v12, v13
    v_cvt_pk_bf16_f32 v30, v14, v15
    v_lshlrev_b32 v8, 16, v24
    v_and_b32 v9, 0xffff0000, v24
    v_lshlrev_b32 v10, 16, v26
    v_and_b32 v11, 0xffff0000, v26
    v_lshlrev_b32 v12, 16, v28
    v_and_b32 v13, 0xffff0000, v28
    v_lshlrev_b32 v14, 16, v30
    v_and_b32 v15, 0xffff0000, v30
    v_max3_f32 v32, v8, v9, v10
    v_max3_f32 v33, v11, v12, v13
    v_max3_f32 v32, v32, v14, v15
    v_max_f32 v32, v32, v33
    s_nop 1
    v_max_f32_dpp v32, v32, v32 quad_perm:[1,0,3,2] row_mask:0xf bank_mask:0xf
    s_nop 1
    v_max_f32_dpp v32, v32, v32 quad_perm:[2,3,0,1] row_mask:0xf bank_mask:0xf
    s_nop 1
    v_max_f32_dpp v32, v32, v32 row_ror:4 row_mask:0xf bank_mask:0xf
    s_nop 1
    v_max_f32_dpp v32, v32, v32 row_ror:8 row_mask:0xf bank_mask:0xf
    v_mov_b32 v33, v32
    s_nop 1
    v_permlane16_swap_b32 v32, v33
    v_max_f32 v32, v32, v33
    v_mov_b32 v33, v32
    s_nop 1
    v_permlane32_swap_b32 v32, v33
    v_max_f32 v32, v32, v33
    v_sub_f32 v8, v8, v32
    v_sub_f32 v9, v9, v32
    v_sub_f32 v10, v10, v32
    v_sub_f32 v11, v11, v32
    v_sub_f32 v12, v12, v32
    v_sub_f32 v13, v13, v32
    v_sub_f32 v14, v14, v32
    v_sub_f32 v15, v15, v32
    v_mul_f32 v8, s57, v8
    v_mul_f32 v9, s57, v9
    v_mul_f32 v10, s57, v10
    v_mul_f32 v11, s57, v11
    v_mul_f32 v12, s57, v12
    v_mul_f32 v13, s57, v13
    v_mul_f32 v14, s57, v14
    v_mul_f32 v15, s57, v15
    v_exp_f32 v8, v8
    v_exp_f32 v9, v9
    v_exp_f32 v10, v10
    v_exp_f32 v11, v11
    v_exp_f32 v12, v12
    v_exp_f32 v13, v13
    v_exp_f32 v14, v14
    v_exp_f32 v15, v15
    v_add_f32 v24, v8, v9
    v_add_f32 v26, v10, v11
    v_add_f32 v28, v12, v13
    v_add_f32 v30, v14, v15
    v_add_f32 v24, v24, v26
    v_add_f32 v28, v28, v30
    v_add_f32 v33, v24, v28
    v_mov_b32_dpp v24, v8 row_ror:8 row_mask:0xf bank_mask:0xf
    v_mov_b32_dpp v25, v9 row_ror:8 row_mask:0xf bank_mask:0xf
    v_mov_b32_dpp v26, v10 row_ror:8 row_mask:0xf bank_mask:0xf
    v_mov_b32_dpp v27, v11 row_ror:8 row_mask:0xf bank_mask:0xf
    v_mov_b32_dpp v28, v12 row_ror:8 row_mask:0xf bank_mask:0xf
    v_mov_b32_dpp v29, v13 row_ror:8 row_mask:0xf bank_mask:0xf
    v_mov_b32_dpp v30, v14 row_ror:8 row_mask:0xf bank_mask:0xf
    v_mov_b32_dpp v31, v15 row_ror:8 row_mask:0xf bank_mask:0xf
    v_cvt_pk_bf16_f32 v8, v8, v24
    v_cvt_pk_bf16_f32 v9, v9, v25
    v_cvt_pk_bf16_f32 v10, v10, v26
    v_cvt_pk_bf16_f32 v11, v11, v27
    v_cvt_pk_bf16_f32 v12, v12, v28
    v_cvt_pk_bf16_f32 v13, v13, v29
    v_cvt_pk_bf16_f32 v14, v14, v30
    v_cvt_pk_bf16_f32 v15, v15, v31
    v_add_f32_dpp v33, v33, v33 quad_perm:[1,0,3,2] row_mask:0xf bank_mask:0xf
    s_nop 1
    v_add_f32_dpp v33, v33, v33 quad_perm:[2,3,0,1] row_mask:0xf bank_mask:0xf
    s_nop 1
    v_add_f32_dpp v33, v33, v33 row_ror:8 row_mask:0xf bank_mask:0xf
    s_nop 1
    v_add_f32_dpp v33, v33, v33 row_ror:4 row_mask:0xf bank_mask:0xf
    v_mov_b32 v36, v33
    s_nop 1
    v_permlane16_swap_b32 v33, v36
    v_add_f32 v33, v33, v36
    v_mov_b32 v36, v33
    s_nop 1
    v_permlane32_swap_b32 v33, v36
    v_add_f32 v33, v33, v36
    v_mov_b32 v34, 1
    v_mov_b32 v35, 0
    s_lshl_b32 s56, s3, 4
    v_mov_b32 v36, s56
    s_mov_b64 exec, 1
    ds_write_b128 v36, v[32:35] offset:1024
    s_mov_b64 exec, -1
    s_mov_b32 s59, 0
    v_mov_b32 v47, 1
    v_mov_b32 v48, 0
.p2align 6
L_vloop:
    s_nop 4
    v_perm_b32 v24, v68, v64, s35
    v_perm_b32 v25, v68, v64, s36
    v_perm_b32 v26, v69, v65, s35
    v_perm_b32 v27, v69, v65, s36
    v_perm_b32 v28, v70, v66, s35
    v_perm_b32 v29, v70, v66, s36
    v_perm_b32 v30, v71, v67, s35
    v_perm_b32 v31, v71, v67, s36
    s_add_u32 s58, s60, 0
    s_cmp_ge_u32 s59, 2
    s_cbranch_scc1 L_vf0_0
    s_waitcnt vmcnt(4)
L_vf0_0:
    s_waitcnt vmcnt(10)
    buffer_load_dwordx4 v[64:67], v50, s[40:43], s58 offen offset:0 nt
    buffer_load_dwordx4 v[68:71], v50, s[40:43], s58 offen offset:1024 nt
    v_dot2c_f32_bf16_dpp v16, v8, v24 row_newbcast:0 row_mask:0xf bank_mask:0xf
    v_dot2c_f32_bf16_dpp v17, v8, v25 row_newbcast:0 row_mask:0xf bank_mask:0xf
    v_dot2c_f32_bf16_dpp v18, v8, v26 row_newbcast:0 row_mask:0xf bank_mask:0xf
    v_dot2c_f32_bf16_dpp v19, v8, v27 row_newbcast:0 row_mask:0xf bank_mask:0xf
    v_dot2c_f32_bf16_dpp v20, v8, v28 row_newbcast:0 row_mask:0xf bank_mask:0xf
    v_dot2c_f32_bf16_dpp v21, v8, v29 row_newbcast:0 row_mask:0xf bank_mask:0xf
    v_dot2c_f32_bf16_dpp v22, v8, v30 row_newbcast:0 row_mask:0xf bank_mask:0xf
    v_dot2c_f32_bf16_dpp v23, v8, v31 row_newbcast:0 row_mask:0xf bank_mask:0xf
    v_perm_b32 v32, v76, v72, s35
    v_perm_b32 v33, v76, v72, s36
    v_perm_b32 v34, v77, v73, s35
    v_perm_b32 v35, v77, v73, s36
    v_perm_b32 v36, v78, v74, s35
    v_perm_b32 v37, v78, v74, s36
    v_perm_b32 v38, v79, v75, s35
    v_perm_b32 v39, v79, v75, s36
    s_cmp_ge_u32 s59, 2
    s_cbranch_scc1 L_vf0_1
    s_waitcnt vmcnt(4)
L_vf0_1:
    s_waitcnt vmcnt(10)
    buffer_load_dwordx4 v[72:75], v50, s[40:43], s58 offen offset:2048 nt
    buffer_load_dwordx4 v[76:79], v50, s[40:43], s58 offen offset:3072 nt
    v_dot2c_f32_bf16_dpp v16, v8, v32 row_newbcast:4 row_mask:0xf bank_mask:0xf
    v_dot2c_f32_bf16_dpp v17, v8, v33 row_newbcast:4 row_mask:0xf bank_mask:0xf
    v_dot2c_f32_bf16_dpp v18, v8, v34 row_newbcast:4 row_mask:0xf bank_mask:0xf
    v_dot2c_f32_bf16_dpp v19, v8, v35 row_newbcast:4 row_mask:0xf bank_mask:0xf
    v_dot2c_f32_bf16_dpp v20, v8, v36 row_newbcast:4 row_mask:0xf bank_mask:0xf
    v_dot2c_f32_bf16_dpp v21, v8, v37 row_newbcast:4 row_mask:0xf bank_mask:0xf
    v_dot2c_f32_bf16_dpp v22, v8, v38 row_newbcast:4 row_mask:0xf bank_mask:0xf
    v_dot2c_f32_bf16_dpp v23, v8, v39 row_newbcast:4 row_mask:0xf bank_mask:0xf
    v_perm_b32 v24, v84, v80, s35
    v_perm_b32 v25, v84, v80, s36
    v_perm_b32 v26, v85, v81, s35
    v_perm_b32 v27, v85, v81, s36
    v_perm_b32 v28, v86, v82, s35
    v_perm_b32 v29, v86, v82, s36
    v_perm_b32 v30, v87, v83, s35
    v_perm_b32 v31, v87, v83, s36
    s_add_u32 s58, s60, 16384
    s_cmp_ge_u32 s59, 2
    s_cbranch_scc1 L_vf1_0
    s_waitcnt vmcnt(4)
L_vf1_0:
    s_waitcnt vmcnt(10)
    buffer_load_dwordx4 v[80:83], v50, s[40:43], s58 offen offset:0 nt
    buffer_load_dwordx4 v[84:87], v50, s[40:43], s58 offen offset:1024 nt
    v_dot2c_f32_bf16_dpp v16, v8, v24 row_newbcast:2 row_mask:0xf bank_mask:0xf
    v_dot2c_f32_bf16_dpp v17, v8, v25 row_newbcast:2 row_mask:0xf bank_mask:0xf
    v_dot2c_f32_bf16_dpp v18, v8, v26 row_newbcast:2 row_mask:0xf bank_mask:0xf
    v_dot2c_f32_bf16_dpp v19, v8, v27 row_newbcast:2 row_mask:0xf bank_mask:0xf
    v_dot2c_f32_bf16_dpp v20, v8, v28 row_newbcast:2 row_mask:0xf bank_mask:0xf
    v_dot2c_f32_bf16_dpp v21, v8, v29 row_newbcast:2 row_mask:0xf bank_mask:0xf
    v_dot2c_f32_bf16_dpp v22, v8, v30 row_newbcast:2 row_mask:0xf bank_mask:0xf
    v_dot2c_f32_bf16_dpp v23, v8, v31 row_newbcast:2 row_mask:0xf bank_mask:0xf
    v_perm_b32 v32, v92, v88, s35
    v_perm_b32 v33, v92, v88, s36
    v_perm_b32 v34, v93, v89, s35
    v_perm_b32 v35, v93, v89, s36
    v_perm_b32 v36, v94, v90, s35
    v_perm_b32 v37, v94, v90, s36
    v_perm_b32 v38, v95, v91, s35
    v_perm_b32 v39, v95, v91, s36
    s_cmp_ge_u32 s59, 2
    s_cbranch_scc1 L_vf1_1
    s_waitcnt vmcnt(4)
L_vf1_1:
    s_waitcnt vmcnt(10)
    buffer_load_dwordx4 v[88:91], v50, s[40:43], s58 offen offset:2048 nt
    buffer_load_dwordx4 v[92:95], v50, s[40:43], s58 offen offset:3072 nt
    v_dot2c_f32_bf16_dpp v16, v8, v32 row_newbcast:6 row_mask:0xf bank_mask:0xf
    v_dot2c_f32_bf16_dpp v17, v8, v33 row_newbcast:6 row_mask:0xf bank_mask:0xf
    v_dot2c_f32_bf16_dpp v18, v8, v34 row_newbcast:6 row_mask:0xf bank_mask:0xf
    v_dot2c_f32_bf16_dpp v19, v8, v35 row_newbcast:6 row_mask:0xf bank_mask:0xf
    v_dot2c_f32_bf16_dpp v20, v8, v36 row_newbcast:6 row_mask:0xf bank_mask:0xf
    v_dot2c_f32_bf16_dpp v21, v8, v37 row_newbcast:6 row_mask:0xf bank_mask:0xf
    v_dot2c_f32_bf16_dpp v22, v8, v38 row_newbcast:6 row_mask:0xf bank_mask:0xf
    v_dot2c_f32_bf16_dpp v23, v8, v39 row_newbcast:6 row_mask:0xf bank_mask:0xf
    v_perm_b32 v24, v100, v96, s35
    v_perm_b32 v25, v100, v96, s36
    v_perm_b32 v26, v101, v97, s35
    v_perm_b32 v27, v101, v97, s36
    v_perm_b32 v28, v102, v98, s35
    v_perm_b32 v29, v102, v98, s36
    v_perm_b32 v30, v103, v99, s35
    v_perm_b32 v31, v103, v99, s36
    s_add_u32 s58, s60, 32768
    s_cmp_ge_u32 s59, 2
    s_cbranch_scc1 L_vf2_0
    s_waitcnt vmcnt(4)
L_vf2_0:
    s_waitcnt vmcnt(10)
    buffer_load_dwordx4 v[96:99], v50, s[40:43], s58 offen offset:0 nt
    buffer_load_dwordx4 v[100:103], v50, s[40:43], s58 offen offset:1024 nt
    v_dot2c_f32_bf16_dpp v16, v8, v24 row_newbcast:1 row_mask:0xf bank_mask:0xf
    v_dot2c_f32_bf16_dpp v17, v8, v25 row_newbcast:1 row_mask:0xf bank_mask:0xf
    v_dot2c_f32_bf16_dpp v18, v8, v26 row_newbcast:1 row_mask:0xf bank_mask:0xf
    v_dot2c_f32_bf16_dpp v19, v8, v27 row_newbcast:1 row_mask:0xf bank_mask:0xf
    v_dot2c_f32_bf16_dpp v20, v8, v28 row_newbcast:1 row_mask:0xf bank_mask:0xf
    v_dot2c_f32_bf16_dpp v21, v8, v29 row_newbcast:1 row_mask:0xf bank_mask:0xf
    v_dot2c_f32_bf16_dpp v22, v8, v30 row_newbcast:1 row_mask:0xf bank_mask:0xf
    v_dot2c_f32_bf16_dpp v23, v8, v31 row_newbcast:1 row_mask:0xf bank_mask:0xf
    v_perm_b32 v32, v108, v104, s35
    v_perm_b32 v33, v108, v104, s36
    v_perm_b32 v34, v109, v105, s35
    v_perm_b32 v35, v109, v105, s36
    v_perm_b32 v36, v110, v106, s35
    v_perm_b32 v37, v110, v106, s36
    v_perm_b32 v38, v111, v107, s35
    v_perm_b32 v39, v111, v107, s36
    s_cmp_ge_u32 s59, 2
    s_cbranch_scc1 L_vf2_1
    s_waitcnt vmcnt(4)
L_vf2_1:
    s_waitcnt vmcnt(10)
    buffer_load_dwordx4 v[104:107], v50, s[40:43], s58 offen offset:2048 nt
    buffer_load_dwordx4 v[108:111], v50, s[40:43], s58 offen offset:3072 nt
    v_dot2c_f32_bf16_dpp v16, v8, v32 row_newbcast:5 row_mask:0xf bank_mask:0xf
    v_dot2c_f32_bf16_dpp v17, v8, v33 row_newbcast:5 row_mask:0xf bank_mask:0xf
    v_dot2c_f32_bf16_dpp v18, v8, v34 row_newbcast:5 row_mask:0xf bank_mask:0xf
    v_dot2c_f32_bf16_dpp v19, v8, v35 row_newbcast:5 row_mask:0xf bank_mask:0xf
    v_dot2c_f32_bf16_dpp v20, v8, v36 row_newbcast:5 row_mask:0xf bank_mask:0xf
    v_dot2c_f32_bf16_dpp v21, v8, v37 row_newbcast:5 row_mask:0xf bank_mask:0xf
    v_dot2c_f32_bf16_dpp v22, v8, v38 row_newbcast:5 row_mask:0xf bank_mask:0xf
    v_dot2c_f32_bf16_dpp v23, v8, v39 row_newbcast:5 row_mask:0xf bank_mask:0xf
    v_perm_b32 v24, v116, v112, s35
    v_perm_b32 v25, v116, v112, s36
    v_perm_b32 v26, v117, v113, s35
    v_perm_b32 v27, v117, v113, s36
    v_perm_b32 v28, v118, v114, s35
    v_perm_b32 v29, v118, v114, s36
    v_perm_b32 v30, v119, v115, s35
    v_perm_b32 v31, v119, v115, s36
    s_add_u32 s58, s60, 49152
    s_cmp_ge_u32 s59, 2
    s_cbranch_scc1 L_vf3_0
    s_waitcnt vmcnt(4)
L_vf3_0:
    s_waitcnt vmcnt(10)
    buffer_load_dwordx4 v[112:115], v50, s[40:43], s58 offen offset:0 nt
    buffer_load_dwordx4 v[116:119], v50, s[40:43], s58 offen offset:1024 nt
    v_dot2c_f32_bf16_dpp v16, v8, v24 row_newbcast:3 row_mask:0xf bank_mask:0xf
    v_dot2c_f32_bf16_dpp v17, v8, v25 row_newbcast:3 row_mask:0xf bank_mask:0xf
    v_dot2c_f32_bf16_dpp v18, v8, v26 row_newbcast:3 row_mask:0xf bank_mask:0xf
    v_dot2c_f32_bf16_dpp v19, v8, v27 row_newbcast:3 row_mask:0xf bank_mask:0xf
    v_dot2c_f32_bf16_dpp v20, v8, v28 row_newbcast:3 row_mask:0xf bank_mask:0xf
    v_dot2c_f32_bf16_dpp v21, v8, v29 row_newbcast:3 row_mask:0xf bank_mask:0xf
    v_dot2c_f32_bf16_dpp v22, v8, v30 row_newbcast:3 row_mask:0xf bank_mask:0xf
    v_dot2c_f32_bf16_dpp v23, v8, v31 row_newbcast:3 row_mask:0xf bank_mask:0xf
    v_perm_b32 v32, v124, v120, s35
    v_perm_b32 v33, v124, v120, s36
    v_perm_b32 v34, v125, v121, s35
    v_perm_b32 v35, v125, v121, s36
    v_perm_b32 v36, v126, v122, s35
    v_perm_b32 v37, v126, v122, s36
    v_perm_b32 v38, v127, v123, s35
    v_perm_b32 v39, v127, v123, s36
    s_cmp_ge_u32 s59, 2
    s_cbranch_scc1 L_vf3_1
    s_waitcnt vmcnt(4)
L_vf3_1:
    s_waitcnt vmcnt(10)
    buffer_load_dwordx4 v[120:123], v50, s[40:43], s58 offen offset:2048 nt
    buffer_load_dwordx4 v[124:127], v50, s[40:43], s58 offen offset:3072 nt
    v_dot2c_f32_bf16_dpp v16, v8, v32 row_newbcast:7 row_mask:0xf bank_mask:0xf
    v_dot2c_f32_bf16_dpp v17, v8, v33 row_newbcast:7 row_mask:0xf bank_mask:0xf
    v_dot2c_f32_bf16_dpp v18, v8, v34 row_newbcast:7 row_mask:0xf bank_mask:0xf
    v_dot2c_f32_bf16_dpp v19, v8, v35 row_newbcast:7 row_mask:0xf bank_mask:0xf
    v_dot2c_f32_bf16_dpp v20, v8, v36 row_newbcast:7 row_mask:0xf bank_mask:0xf
    v_dot2c_f32_bf16_dpp v21, v8, v37 row_newbcast:7 row_mask:0xf bank_mask:0xf
    v_dot2c_f32_bf16_dpp v22, v8, v38 row_newbcast:7 row_mask:0xf bank_mask:0xf
    v_dot2c_f32_bf16_dpp v23, v8, v39 row_newbcast:7 row_mask:0xf bank_mask:0xf
    v_perm_b32 v24, v132, v128, s35
    v_perm_b32 v25, v132, v128, s36
    v_perm_b32 v26, v133, v129, s35
    v_perm_b32 v27, v133, v129, s36
    v_perm_b32 v28, v134, v130, s35
    v_perm_b32 v29, v134, v130, s36
    v_perm_b32 v30, v135, v131, s35
    v_perm_b32 v31, v135, v131, s36
    s_add_u32 s58, s60, 65536
    s_cmp_ge_u32 s59, 2
    s_cbranch_scc1 L_vf4_0
    s_waitcnt vmcnt(4)
L_vf4_0:
    s_waitcnt vmcnt(10)
    buffer_load_dwordx4 v[128:131], v50, s[40:43], s58 offen offset:0 nt
    buffer_load_dwordx4 v[132:135], v50, s[40:43], s58 offen offset:1024 nt
    v_dot2c_f32_bf16_dpp v16, v9, v24 row_newbcast:0 row_mask:0xf bank_mask:0xf
    v_dot2c_f32_bf16_dpp v17, v9, v25 row_newbcast:0 row_mask:0xf bank_mask:0xf
    v_dot2c_f32_bf16_dpp v18, v9, v26 row_newbcast:0 row_mask:0xf bank_mask:0xf
    v_dot2c_f32_bf16_dpp v19, v9, v27 row_newbcast:0 row_mask:0xf bank_mask:0xf
    v_dot2c_f32_bf16_dpp v20, v9, v28 row_newbcast:0 row_mask:0xf bank_mask:0xf
    v_dot2c_f32_bf16_dpp v21, v9, v29 row_newbcast:0 row_mask:0xf bank_mask:0xf
    v_dot2c_f32_bf16_dpp v22, v9, v30 row_newbcast:0 row_mask:0xf bank_mask:0xf
    v_dot2c_f32_bf16_dpp v23, v9, v31 row_newbcast:0 row_mask:0xf bank_mask:0xf
    v_perm_b32 v32, v140, v136, s35
    v_perm_b32 v33, v140, v136, s36
    v_perm_b32 v34, v141, v137, s35
    v_perm_b32 v35, v141, v137, s36
    v_perm_b32 v36, v142, v138, s35
    v_perm_b32 v37, v142, v138, s36
    v_perm_b32 v38, v143, v139, s35
    v_perm_b32 v39, v143, v139, s36
    s_cmp_ge_u32 s59, 2
    s_cbranch_scc1 L_vf4_1
    s_waitcnt vmcnt(4)
L_vf4_1:
    s_waitcnt vmcnt(10)
    buffer_load_dwordx4 v[136:139], v50, s[40:43], s58 offen offset:2048 nt
    buffer_load_dwordx4 v[140:143], v50, s[40:43], s58 offen offset:3072 nt
    v_dot2c_f32_bf16_dpp v16, v9, v32 row_newbcast:4 row_mask:0xf bank_mask:0xf
    v_dot2c_f32_bf16_dpp v17, v9, v33 row_newbcast:4 row_mask:0xf bank_mask:0xf
    v_dot2c_f32_bf16_dpp v18, v9, v34 row_newbcast:4 row_mask:0xf bank_mask:0xf
    v_dot2c_f32_bf16_dpp v19, v9, v35 row_newbcast:4 row_mask:0xf bank_mask:0xf
    v_dot2c_f32_bf16_dpp v20, v9, v36 row_newbcast:4 row_mask:0xf bank_mask:0xf
    v_dot2c_f32_bf16_dpp v21, v9, v37 row_newbcast:4 row_mask:0xf bank_mask:0xf
    v_dot2c_f32_bf16_dpp v22, v9, v38 row_newbcast:4 row_mask:0xf bank_mask:0xf
    v_dot2c_f32_bf16_dpp v23, v9, v39 row_newbcast:4 row_mask:0xf bank_mask:0xf
    v_perm_b32 v24, v148, v144, s35
    v_perm_b32 v25, v148, v144, s36
    v_perm_b32 v26, v149, v145, s35
    v_perm_b32 v27, v149, v145, s36
    v_perm_b32 v28, v150, v146, s35
    v_perm_b32 v29, v150, v146, s36
    v_perm_b32 v30, v151, v147, s35
    v_perm_b32 v31, v151, v147, s36
    s_add_u32 s58, s60, 81920
    s_cmp_ge_u32 s59, 2
    s_cbranch_scc1 L_vf5_0
    s_waitcnt vmcnt(4)
L_vf5_0:
    s_waitcnt vmcnt(10)
    buffer_load_dwordx4 v[144:147], v50, s[40:43], s58 offen offset:0 nt
    buffer_load_dwordx4 v[148:151], v50, s[40:43], s58 offen offset:1024 nt
    v_dot2c_f32_bf16_dpp v16, v9, v24 row_newbcast:2 row_mask:0xf bank_mask:0xf
    v_dot2c_f32_bf16_dpp v17, v9, v25 row_newbcast:2 row_mask:0xf bank_mask:0xf
    v_dot2c_f32_bf16_dpp v18, v9, v26 row_newbcast:2 row_mask:0xf bank_mask:0xf
    v_dot2c_f32_bf16_dpp v19, v9, v27 row_newbcast:2 row_mask:0xf bank_mask:0xf
    v_dot2c_f32_bf16_dpp v20, v9, v28 row_newbcast:2 row_mask:0xf bank_mask:0xf
    v_dot2c_f32_bf16_dpp v21, v9, v29 row_newbcast:2 row_mask:0xf bank_mask:0xf
    v_dot2c_f32_bf16_dpp v22, v9, v30 row_newbcast:2 row_mask:0xf bank_mask:0xf
    v_dot2c_f32_bf16_dpp v23, v9, v31 row_newbcast:2 row_mask:0xf bank_mask:0xf
    v_perm_b32 v32, v156, v152, s35
    v_perm_b32 v33, v156, v152, s36
    v_perm_b32 v34, v157, v153, s35
    v_perm_b32 v35, v157, v153, s36
    v_perm_b32 v36, v158, v154, s35
    v_perm_b32 v37, v158, v154, s36
    v_perm_b32 v38, v159, v155, s35
    v_perm_b32 v39, v159, v155, s36
    s_cmp_ge_u32 s59, 2
    s_cbranch_scc1 L_vf5_1
    s_waitcnt vmcnt(4)
L_vf5_1:
    s_waitcnt vmcnt(10)
    buffer_load_dwordx4 v[152:155], v50, s[40:43], s58 offen offset:2048 nt
    buffer_load_dwordx4 v[156:159], v50, s[40:43], s58 offen offset:3072 nt
    v_dot2c_f32_bf16_dpp v16, v9, v32 row_newbcast:6 row_mask:0xf bank_mask:0xf
    v_dot2c_f32_bf16_dpp v17, v9, v33 row_newbcast:6 row_mask:0xf bank_mask:0xf
    v_dot2c_f32_bf16_dpp v18, v9, v34 row_newbcast:6 row_mask:0xf bank_mask:0xf
    v_dot2c_f32_bf16_dpp v19, v9, v35 row_newbcast:6 row_mask:0xf bank_mask:0xf
    v_dot2c_f32_bf16_dpp v20, v9, v36 row_newbcast:6 row_mask:0xf bank_mask:0xf
    v_dot2c_f32_bf16_dpp v21, v9, v37 row_newbcast:6 row_mask:0xf bank_mask:0xf
    v_dot2c_f32_bf16_dpp v22, v9, v38 row_newbcast:6 row_mask:0xf bank_mask:0xf
    v_dot2c_f32_bf16_dpp v23, v9, v39 row_newbcast:6 row_mask:0xf bank_mask:0xf
    v_perm_b32 v24, v164, v160, s35
    v_perm_b32 v25, v164, v160, s36
    v_perm_b32 v26, v165, v161, s35
    v_perm_b32 v27, v165, v161, s36
    v_perm_b32 v28, v166, v162, s35
    v_perm_b32 v29, v166, v162, s36
    v_perm_b32 v30, v167, v163, s35
    v_perm_b32 v31, v167, v163, s36
    s_add_u32 s58, s60, 98304
    s_cmp_ge_u32 s59, 2
    s_cbranch_scc1 L_vf6_0
    s_waitcnt vmcnt(4)
L_vf6_0:
    s_waitcnt vmcnt(10)
    buffer_load_dwordx4 v[160:163], v50, s[40:43], s58 offen offset:0 nt
    buffer_load_dwordx4 v[164:167], v50, s[40:43], s58 offen offset:1024 nt
    v_dot2c_f32_bf16_dpp v16, v9, v24 row_newbcast:1 row_mask:0xf bank_mask:0xf
    v_dot2c_f32_bf16_dpp v17, v9, v25 row_newbcast:1 row_mask:0xf bank_mask:0xf
    v_dot2c_f32_bf16_dpp v18, v9, v26 row_newbcast:1 row_mask:0xf bank_mask:0xf
    v_dot2c_f32_bf16_dpp v19, v9, v27 row_newbcast:1 row_mask:0xf bank_mask:0xf
    v_dot2c_f32_bf16_dpp v20, v9, v28 row_newbcast:1 row_mask:0xf bank_mask:0xf
    v_dot2c_f32_bf16_dpp v21, v9, v29 row_newbcast:1 row_mask:0xf bank_mask:0xf
    v_dot2c_f32_bf16_dpp v22, v9, v30 row_newbcast:1 row_mask:0xf bank_mask:0xf
    v_dot2c_f32_bf16_dpp v23, v9, v31 row_newbcast:1 row_mask:0xf bank_mask:0xf
    v_perm_b32 v32, v172, v168, s35
    v_perm_b32 v33, v172, v168, s36
    v_perm_b32 v34, v173, v169, s35
    v_perm_b32 v35, v173, v169, s36
    v_perm_b32 v36, v174, v170, s35
    v_perm_b32 v37, v174, v170, s36
    v_perm_b32 v38, v175, v171, s35
    v_perm_b32 v39, v175, v171, s36
    s_cmp_ge_u32 s59, 2
    s_cbranch_scc1 L_vf6_1
    s_waitcnt vmcnt(4)
L_vf6_1:
    s_waitcnt vmcnt(10)
    buffer_load_dwordx4 v[168:171], v50, s[40:43], s58 offen offset:2048 nt
    buffer_load_dwordx4 v[172:175], v50, s[40:43], s58 offen offset:3072 nt
    v_dot2c_f32_bf16_dpp v16, v9, v32 row_newbcast:5 row_mask:0xf bank_mask:0xf
    v_dot2c_f32_bf16_dpp v17, v9, v33 row_newbcast:5 row_mask:0xf bank_mask:0xf
    v_dot2c_f32_bf16_dpp v18, v9, v34 row_newbcast:5 row_mask:0xf bank_mask:0xf
    v_dot2c_f32_bf16_dpp v19, v9, v35 row_newbcast:5 row_mask:0xf bank_mask:0xf
    v_dot2c_f32_bf16_dpp v20, v9, v36 row_newbcast:5 row_mask:0xf bank_mask:0xf
    v_dot2c_f32_bf16_dpp v21, v9, v37 row_newbcast:5 row_mask:0xf bank_mask:0xf
    v_dot2c_f32_bf16_dpp v22, v9, v38 row_newbcast:5 row_mask:0xf bank_mask:0xf
    v_dot2c_f32_bf16_dpp v23, v9, v39 row_newbcast:5 row_mask:0xf bank_mask:0xf
    v_perm_b32 v24, v180, v176, s35
    v_perm_b32 v25, v180, v176, s36
    v_perm_b32 v26, v181, v177, s35
    v_perm_b32 v27, v181, v177, s36
    v_perm_b32 v28, v182, v178, s35
    v_perm_b32 v29, v182, v178, s36
    v_perm_b32 v30, v183, v179, s35
    v_perm_b32 v31, v183, v179, s36
    s_add_u32 s58, s60, 114688
    s_cmp_ge_u32 s59, 2
    s_cbranch_scc1 L_vf7_0
    s_waitcnt vmcnt(4)
L_vf7_0:
    s_waitcnt vmcnt(10)
    buffer_load_dwordx4 v[176:179], v50, s[40:43], s58 offen offset:0 nt
    buffer_load_dwordx4 v[180:183], v50, s[40:43], s58 offen offset:1024 nt
    v_dot2c_f32_bf16_dpp v16, v9, v24 row_newbcast:3 row_mask:0xf bank_mask:0xf
    v_dot2c_f32_bf16_dpp v17, v9, v25 row_newbcast:3 row_mask:0xf bank_mask:0xf
    v_dot2c_f32_bf16_dpp v18, v9, v26 row_newbcast:3 row_mask:0xf bank_mask:0xf
    v_dot2c_f32_bf16_dpp v19, v9, v27 row_newbcast:3 row_mask:0xf bank_mask:0xf
    v_dot2c_f32_bf16_dpp v20, v9, v28 row_newbcast:3 row_mask:0xf bank_mask:0xf
    v_dot2c_f32_bf16_dpp v21, v9, v29 row_newbcast:3 row_mask:0xf bank_mask:0xf
    v_dot2c_f32_bf16_dpp v22, v9, v30 row_newbcast:3 row_mask:0xf bank_mask:0xf
    v_dot2c_f32_bf16_dpp v23, v9, v31 row_newbcast:3 row_mask:0xf bank_mask:0xf
    v_perm_b32 v32, v188, v184, s35
    v_perm_b32 v33, v188, v184, s36
    v_perm_b32 v34, v189, v185, s35
    v_perm_b32 v35, v189, v185, s36
    v_perm_b32 v36, v190, v186, s35
    v_perm_b32 v37, v190, v186, s36
    v_perm_b32 v38, v191, v187, s35
    v_perm_b32 v39, v191, v187, s36
    s_cmp_ge_u32 s59, 2
    s_cbranch_scc1 L_vf7_1
    s_waitcnt vmcnt(4)
L_vf7_1:
    s_waitcnt vmcnt(10)
    buffer_load_dwordx4 v[184:187], v50, s[40:43], s58 offen offset:2048 nt
    buffer_load_dwordx4 v[188:191], v50, s[40:43], s58 offen offset:3072 nt
    v_dot2c_f32_bf16_dpp v16, v9, v32 row_newbcast:7 row_mask:0xf bank_mask:0xf
    v_dot2c_f32_bf16_dpp v17, v9, v33 row_newbcast:7 row_mask:0xf bank_mask:0xf
    v_dot2c_f32_bf16_dpp v18, v9, v34 row_newbcast:7 row_mask:0xf bank_mask:0xf
    v_dot2c_f32_bf16_dpp v19, v9, v35 row_newbcast:7 row_mask:0xf bank_mask:0xf
    v_dot2c_f32_bf16_dpp v20, v9, v36 row_newbcast:7 row_mask:0xf bank_mask:0xf
    v_dot2c_f32_bf16_dpp v21, v9, v37 row_newbcast:7 row_mask:0xf bank_mask:0xf
    v_dot2c_f32_bf16_dpp v22, v9, v38 row_newbcast:7 row_mask:0xf bank_mask:0xf
    v_dot2c_f32_bf16_dpp v23, v9, v39 row_newbcast:7 row_mask:0xf bank_mask:0xf
    v_mov_b32 v8, v10
    v_mov_b32 v9, v11
    v_mov_b32 v10, v12
    v_mov_b32 v11, v13
    v_mov_b32 v12, v14
    v_mov_b32 v13, v15
    s_add_u32 s60, s60, 131072
    s_add_u32 s59, s59, 1
    v_min_u32 v46, s59, v47
    ds_write_b32 v48, v46 offset:1152
    s_cmp_lt_u32 s59, 3
    s_cbranch_scc1 L_vloop
    s_mov_b32 s57, 960000
L_pc2:
    s_nop 4
    ds_read_b64 v[42:43], v41 offset:1120
    s_waitcnt lgkmcnt(0)
    v_cmp_ne_u32 vcc, 1, v43
    s_cbranch_vccz L_pc2_ok
    s_sleep 1
    s_sub_u32 s57, s57, 1
    s_cbranch_scc0 L_pc2
L_pc2_ok:
    s_waitcnt vmcnt(30)
    v_perm_b32 v24, v68, v64, s35
    v_perm_b32 v25, v68, v64, s36
    v_perm_b32 v26, v69, v65, s35
    v_perm_b32 v27, v69, v65, s36
    v_perm_b32 v28, v70, v66, s35
    v_perm_b32 v29, v70, v66, s36
    v_perm_b32 v30, v71, v67, s35
    v_perm_b32 v31, v71, v67, s36
    v_dot2c_f32_bf16_dpp v16, v8, v24 row_newbcast:0 row_mask:0xf bank_mask:0xf
    v_dot2c_f32_bf16_dpp v17, v8, v25 row_newbcast:0 row_mask:0xf bank_mask:0xf
    v_dot2c_f32_bf16_dpp v18, v8, v26 row_newbcast:0 row_mask:0xf bank_mask:0xf
    v_dot2c_f32_bf16_dpp v19, v8, v27 row_newbcast:0 row_mask:0xf bank_mask:0xf
    v_dot2c_f32_bf16_dpp v20, v8, v28 row_newbcast:0 row_mask:0xf bank_mask:0xf
    v_dot2c_f32_bf16_dpp v21, v8, v29 row_newbcast:0 row_mask:0xf bank_mask:0xf
    v_dot2c_f32_bf16_dpp v22, v8, v30 row_newbcast:0 row_mask:0xf bank_mask:0xf
    v_dot2c_f32_bf16_dpp v23, v8, v31 row_newbcast:0 row_mask:0xf bank_mask:0xf
    s_waitcnt vmcnt(28)
    v_perm_b32 v32, v76, v72, s35
    v_perm_b32 v33, v76, v72, s36
    v_perm_b32 v34, v77, v73, s35
    v_perm_b32 v35, v77, v73, s36
    v_perm_b32 v36, v78, v74, s35
    v_perm_b32 v37, v78, v74, s36
    v_perm_b32 v38, v79, v75, s35
    v_perm_b32 v39, v79, v75, s36
    v_dot2c_f32_bf16_dpp v16, v8, v32 row_newbcast:4 row_mask:0xf bank_mask:0xf
    v_dot2c_f32_bf16_dpp v17, v8, v33 row_newbcast:4 row_mask:0xf bank_mask:0xf
    v_dot2c_f32_bf16_dpp v18, v8, v34 row_newbcast:4 row_mask:0xf bank_mask:0xf
    v_dot2c_f32_bf16_dpp v19, v8, v35 row_newbcast:4 row_mask:0xf bank_mask:0xf
    v_dot2c_f32_bf16_dpp v20, v8, v36 row_newbcast:4 row_mask:0xf bank_mask:0xf
    v_dot2c_f32_bf16_dpp v21, v8, v37 row_newbcast:4 row_mask:0xf bank_mask:0xf
    v_dot2c_f32_bf16_dpp v22, v8, v38 row_newbcast:4 row_mask:0xf bank_mask:0xf
    v_dot2c_f32_bf16_dpp v23, v8, v39 row_newbcast:4 row_mask:0xf bank_mask:0xf
    s_waitcnt vmcnt(26)
    v_perm_b32 v24, v84, v80, s35
    v_perm_b32 v25, v84, v80, s36
    v_perm_b32 v26, v85, v81, s35
    v_perm_b32 v27, v85, v81, s36
    v_perm_b32 v28, v86, v82, s35
    v_perm_b32 v29, v86, v82, s36
    v_perm_b32 v30, v87, v83, s35
    v_perm_b32 v31, v87, v83, s36
    v_dot2c_f32_bf16_dpp v16, v8, v24 row_newbcast:2 row_mask:0xf bank_mask:0xf
    v_dot2c_f32_bf16_dpp v17, v8, v25 row_newbcast:2 row_mask:0xf bank_mask:0xf
    v_dot2c_f32_bf16_dpp v18, v8, v26 row_newbcast:2 row_mask:0xf bank_mask:0xf
    v_dot2c_f32_bf16_dpp v19, v8, v27 row_newbcast:2 row_mask:0xf bank_mask:0xf
    v_dot2c_f32_bf16_dpp v20, v8, v28 row_newbcast:2 row_mask:0xf bank_mask:0xf
    v_dot2c_f32_bf16_dpp v21, v8, v29 row_newbcast:2 row_mask:0xf bank_mask:0xf
    v_dot2c_f32_bf16_dpp v22, v8, v30 row_newbcast:2 row_mask:0xf bank_mask:0xf
    v_dot2c_f32_bf16_dpp v23, v8, v31 row_newbcast:2 row_mask:0xf bank_mask:0xf
    s_waitcnt vmcnt(24)
    v_perm_b32 v32, v92, v88, s35
    v_perm_b32 v33, v92, v88, s36
    v_perm_b32 v34, v93, v89, s35
    v_perm_b32 v35, v93, v89, s36
    v_perm_b32 v36, v94, v90, s35
    v_perm_b32 v37, v94, v90, s36
    v_perm_b32 v38, v95, v91, s35
    v_perm_b32 v39, v95, v91, s36
    v_dot2c_f32_bf16_dpp v16, v8, v32 row_newbcast:6 row_mask:0xf bank_mask:0xf
    v_dot2c_f32_bf16_dpp v17, v8, v33 row_newbcast:6 row_mask:0xf bank_mask:0xf
    v_dot2c_f32_bf16_dpp v18, v8, v34 row_newbcast:6 row_mask:0xf bank_mask:0xf
    v_dot2c_f32_bf16_dpp v19, v8, v35 row_newbcast:6 row_mask:0xf bank_mask:0xf
    v_dot2c_f32_bf16_dpp v20, v8, v36 row_newbcast:6 row_mask:0xf bank_mask:0xf
    v_dot2c_f32_bf16_dpp v21, v8, v37 row_newbcast:6 row_mask:0xf bank_mask:0xf
    v_dot2c_f32_bf16_dpp v22, v8, v38 row_newbcast:6 row_mask:0xf bank_mask:0xf
    v_dot2c_f32_bf16_dpp v23, v8, v39 row_newbcast:6 row_mask:0xf bank_mask:0xf
    s_waitcnt vmcnt(22)
    v_perm_b32 v24, v100, v96, s35
    v_perm_b32 v25, v100, v96, s36
    v_perm_b32 v26, v101, v97, s35
    v_perm_b32 v27, v101, v97, s36
    v_perm_b32 v28, v102, v98, s35
    v_perm_b32 v29, v102, v98, s36
    v_perm_b32 v30, v103, v99, s35
    v_perm_b32 v31, v103, v99, s36
    v_dot2c_f32_bf16_dpp v16, v8, v24 row_newbcast:1 row_mask:0xf bank_mask:0xf
    v_dot2c_f32_bf16_dpp v17, v8, v25 row_newbcast:1 row_mask:0xf bank_mask:0xf
    v_dot2c_f32_bf16_dpp v18, v8, v26 row_newbcast:1 row_mask:0xf bank_mask:0xf
    v_dot2c_f32_bf16_dpp v19, v8, v27 row_newbcast:1 row_mask:0xf bank_mask:0xf
    v_dot2c_f32_bf16_dpp v20, v8, v28 row_newbcast:1 row_mask:0xf bank_mask:0xf
    v_dot2c_f32_bf16_dpp v21, v8, v29 row_newbcast:1 row_mask:0xf bank_mask:0xf
    v_dot2c_f32_bf16_dpp v22, v8, v30 row_newbcast:1 row_mask:0xf bank_mask:0xf
    v_dot2c_f32_bf16_dpp v23, v8, v31 row_newbcast:1 row_mask:0xf bank_mask:0xf
    s_waitcnt vmcnt(20)
    v_perm_b32 v32, v108, v104, s35
    v_perm_b32 v33, v108, v104, s36
    v_perm_b32 v34, v109, v105, s35
    v_perm_b32 v35, v109, v105, s36
    v_perm_b32 v36, v110, v106, s35
    v_perm_b32 v37, v110, v106, s36
    v_perm_b32 v38, v111, v107, s35
    v_perm_b32 v39, v111, v107, s36
    v_dot2c_f32_bf16_dpp v16, v8, v32 row_newbcast:5 row_mask:0xf bank_mask:0xf
    v_dot2c_f32_bf16_dpp v17, v8, v33 row_newbcast:5 row_mask:0xf bank_mask:0xf
    v_dot2c_f32_bf16_dpp v18, v8, v34 row_newbcast:5 row_mask:0xf bank_mask:0xf
    v_dot2c_f32_bf16_dpp v19, v8, v35 row_newbcast:5 row_mask:0xf bank_mask:0xf
    v_dot2c_f32_bf16_dpp v20, v8, v36 row_newbcast:5 row_mask:0xf bank_mask:0xf
    v_dot2c_f32_bf16_dpp v21, v8, v37 row_newbcast:5 row_mask:0xf bank_mask:0xf
    v_dot2c_f32_bf16_dpp v22, v8, v38 row_newbcast:5 row_mask:0xf bank_mask:0xf
    v_dot2c_f32_bf16_dpp v23, v8, v39 row_newbcast:5 row_mask:0xf bank_mask:0xf
    s_waitcnt vmcnt(18)
    v_perm_b32 v24, v116, v112, s35
    v_perm_b32 v25, v116, v112, s36
    v_perm_b32 v26, v117, v113, s35
    v_perm_b32 v27, v117, v113, s36
    v_perm_b32 v28, v118, v114, s35
    v_perm_b32 v29, v118, v114, s36
    v_perm_b32 v30, v119, v115, s35
    v_perm_b32 v31, v119, v115, s36
    v_dot2c_f32_bf16_dpp v16, v8, v24 row_newbcast:3 row_mask:0xf bank_mask:0xf
    v_dot2c_f32_bf16_dpp v17, v8, v25 row_newbcast:3 row_mask:0xf bank_mask:0xf
    v_dot2c_f32_bf16_dpp v18, v8, v26 row_newbcast:3 row_mask:0xf bank_mask:0xf
    v_dot2c_f32_bf16_dpp v19, v8, v27 row_newbcast:3 row_mask:0xf bank_mask:0xf
    v_dot2c_f32_bf16_dpp v20, v8, v28 row_newbcast:3 row_mask:0xf bank_mask:0xf
    v_dot2c_f32_bf16_dpp v21, v8, v29 row_newbcast:3 row_mask:0xf bank_mask:0xf
    v_dot2c_f32_bf16_dpp v22, v8, v30 row_newbcast:3 row_mask:0xf bank_mask:0xf
    v_dot2c_f32_bf16_dpp v23, v8, v31 row_newbcast:3 row_mask:0xf bank_mask:0xf
    s_waitcnt vmcnt(16)
    v_perm_b32 v32, v124, v120, s35
    v_perm_b32 v33, v124, v120, s36
    v_perm_b32 v34, v125, v121, s35
    v_perm_b32 v35, v125, v121, s36
    v_perm_b32 v36, v126, v122, s35
    v_perm_b32 v37, v126, v122, s36
    v_perm_b32 v38, v127, v123, s35
    v_perm_b32 v39, v127, v123, s36
    v_dot2c_f32_bf16_dpp v16, v8, v32 row_newbcast:7 row_mask:0xf bank_mask:0xf
    v_dot2c_f32_bf16_dpp v17, v8, v33 row_newbcast:7 row_mask:0xf bank_mask:0xf
    v_dot2c_f32_bf16_dpp v18, v8, v34 row_newbcast:7 row_mask:0xf bank_mask:0xf
    v_dot2c_f32_bf16_dpp v19, v8, v35 row_newbcast:7 row_mask:0xf bank_mask:0xf
    v_dot2c_f32_bf16_dpp v20, v8, v36 row_newbcast:7 row_mask:0xf bank_mask:0xf
    v_dot2c_f32_bf16_dpp v21, v8, v37 row_newbcast:7 row_mask:0xf bank_mask:0xf
    v_dot2c_f32_bf16_dpp v22, v8, v38 row_newbcast:7 row_mask:0xf bank_mask:0xf
    v_dot2c_f32_bf16_dpp v23, v8, v39 row_newbcast:7 row_mask:0xf bank_mask:0xf
    s_waitcnt vmcnt(14)
    v_perm_b32 v24, v132, v128, s35
    v_perm_b32 v25, v132, v128, s36
    v_perm_b32 v26, v133, v129, s35
    v_perm_b32 v27, v133, v129, s36
    v_perm_b32 v28, v134, v130, s35
    v_perm_b32 v29, v134, v130, s36
    v_perm_b32 v30, v135, v131, s35
    v_perm_b32 v31, v135, v131, s36
    v_dot2c_f32_bf16_dpp v16, v9, v24 row_newbcast:0 row_mask:0xf bank_mask:0xf
    v_dot2c_f32_bf16_dpp v17, v9, v25 row_newbcast:0 row_mask:0xf bank_mask:0xf
    v_dot2c_f32_bf16_dpp v18, v9, v26 row_newbcast:0 row_mask:0xf bank_mask:0xf
    v_dot2c_f32_bf16_dpp v19, v9, v27 row_newbcast:0 row_mask:0xf bank_mask:0xf
    v_dot2c_f32_bf16_dpp v20, v9, v28 row_newbcast:0 row_mask:0xf bank_mask:0xf
    v_dot2c_f32_bf16_dpp v21, v9, v29 row_newbcast:0 row_mask:0xf bank_mask:0xf
    v_dot2c_f32_bf16_dpp v22, v9, v30 row_newbcast:0 row_mask:0xf bank_mask:0xf
    v_dot2c_f32_bf16_dpp v23, v9, v31 row_newbcast:0 row_mask:0xf bank_mask:0xf
    s_waitcnt vmcnt(12)
    v_perm_b32 v32, v140, v136, s35
    v_perm_b32 v33, v140, v136, s36
    v_perm_b32 v34, v141, v137, s35
    v_perm_b32 v35, v141, v137, s36
    v_perm_b32 v36, v142, v138, s35
    v_perm_b32 v37, v142, v138, s36
    v_perm_b32 v38, v143, v139, s35
    v_perm_b32 v39, v143, v139, s36
    v_dot2c_f32_bf16_dpp v16, v9, v32 row_newbcast:4 row_mask:0xf bank_mask:0xf
    v_dot2c_f32_bf16_dpp v17, v9, v33 row_newbcast:4 row_mask:0xf bank_mask:0xf
    v_dot2c_f32_bf16_dpp v18, v9, v34 row_newbcast:4 row_mask:0xf bank_mask:0xf
    v_dot2c_f32_bf16_dpp v19, v9, v35 row_newbcast:4 row_mask:0xf bank_mask:0xf
    v_dot2c_f32_bf16_dpp v20, v9, v36 row_newbcast:4 row_mask:0xf bank_mask:0xf
    v_dot2c_f32_bf16_dpp v21, v9, v37 row_newbcast:4 row_mask:0xf bank_mask:0xf
    v_dot2c_f32_bf16_dpp v22, v9, v38 row_newbcast:4 row_mask:0xf bank_mask:0xf
    v_dot2c_f32_bf16_dpp v23, v9, v39 row_newbcast:4 row_mask:0xf bank_mask:0xf
    s_waitcnt vmcnt(10)
    v_perm_b32 v24, v148, v144, s35
    v_perm_b32 v25, v148, v144, s36
    v_perm_b32 v26, v149, v145, s35
    v_perm_b32 v27, v149, v145, s36
    v_perm_b32 v28, v150, v146, s35
    v_perm_b32 v29, v150, v146, s36
    v_perm_b32 v30, v151, v147, s35
    v_perm_b32 v31, v151, v147, s36
    v_dot2c_f32_bf16_dpp v16, v9, v24 row_newbcast:2 row_mask:0xf bank_mask:0xf
    v_dot2c_f32_bf16_dpp v17, v9, v25 row_newbcast:2 row_mask:0xf bank_mask:0xf
    v_dot2c_f32_bf16_dpp v18, v9, v26 row_newbcast:2 row_mask:0xf bank_mask:0xf
    v_dot2c_f32_bf16_dpp v19, v9, v27 row_newbcast:2 row_mask:0xf bank_mask:0xf
    v_dot2c_f32_bf16_dpp v20, v9, v28 row_newbcast:2 row_mask:0xf bank_mask:0xf
    v_dot2c_f32_bf16_dpp v21, v9, v29 row_newbcast:2 row_mask:0xf bank_mask:0xf
    v_dot2c_f32_bf16_dpp v22, v9, v30 row_newbcast:2 row_mask:0xf bank_mask:0xf
    v_dot2c_f32_bf16_dpp v23, v9, v31 row_newbcast:2 row_mask:0xf bank_mask:0xf
    s_waitcnt vmcnt(8)
    v_perm_b32 v32, v156, v152, s35
    v_perm_b32 v33, v156, v152, s36
    v_perm_b32 v34, v157, v153, s35
    v_perm_b32 v35, v157, v153, s36
    v_perm_b32 v36, v158, v154, s35
    v_perm_b32 v37, v158, v154, s36
    v_perm_b32 v38, v159, v155, s35
    v_perm_b32 v39, v159, v155, s36
    v_dot2c_f32_bf16_dpp v16, v9, v32 row_newbcast:6 row_mask:0xf bank_mask:0xf
    v_dot2c_f32_bf16_dpp v17, v9, v33 row_newbcast:6 row_mask:0xf bank_mask:0xf
    v_dot2c_f32_bf16_dpp v18, v9, v34 row_newbcast:6 row_mask:0xf bank_mask:0xf
    v_dot2c_f32_bf16_dpp v19, v9, v35 row_newbcast:6 row_mask:0xf bank_mask:0xf
    v_dot2c_f32_bf16_dpp v20, v9, v36 row_newbcast:6 row_mask:0xf bank_mask:0xf
    v_dot2c_f32_bf16_dpp v21, v9, v37 row_newbcast:6 row_mask:0xf bank_mask:0xf
    v_dot2c_f32_bf16_dpp v22, v9, v38 row_newbcast:6 row_mask:0xf bank_mask:0xf
    v_dot2c_f32_bf16_dpp v23, v9, v39 row_newbcast:6 row_mask:0xf bank_mask:0xf
    s_waitcnt vmcnt(6)
    v_perm_b32 v24, v164, v160, s35
    v_perm_b32 v25, v164, v160, s36
    v_perm_b32 v26, v165, v161, s35
    v_perm_b32 v27, v165, v161, s36
    v_perm_b32 v28, v166, v162, s35
    v_perm_b32 v29, v166, v162, s36
    v_perm_b32 v30, v167, v163, s35
    v_perm_b32 v31, v167, v163, s36
    v_dot2c_f32_bf16_dpp v16, v9, v24 row_newbcast:1 row_mask:0xf bank_mask:0xf
    v_dot2c_f32_bf16_dpp v17, v9, v25 row_newbcast:1 row_mask:0xf bank_mask:0xf
    v_dot2c_f32_bf16_dpp v18, v9, v26 row_newbcast:1 row_mask:0xf bank_mask:0xf
    v_dot2c_f32_bf16_dpp v19, v9, v27 row_newbcast:1 row_mask:0xf bank_mask:0xf
    v_dot2c_f32_bf16_dpp v20, v9, v28 row_newbcast:1 row_mask:0xf bank_mask:0xf
    v_dot2c_f32_bf16_dpp v21, v9, v29 row_newbcast:1 row_mask:0xf bank_mask:0xf
    v_dot2c_f32_bf16_dpp v22, v9, v30 row_newbcast:1 row_mask:0xf bank_mask:0xf
    v_dot2c_f32_bf16_dpp v23, v9, v31 row_newbcast:1 row_mask:0xf bank_mask:0xf
    s_waitcnt vmcnt(4)
    v_perm_b32 v32, v172, v168, s35
    v_perm_b32 v33, v172, v168, s36
    v_perm_b32 v34, v173, v169, s35
    v_perm_b32 v35, v173, v169, s36
    v_perm_b32 v36, v174, v170, s35
    v_perm_b32 v37, v174, v170, s36
    v_perm_b32 v38, v175, v171, s35
    v_perm_b32 v39, v175, v171, s36
    v_dot2c_f32_bf16_dpp v16, v9, v32 row_newbcast:5 row_mask:0xf bank_mask:0xf
    v_dot2c_f32_bf16_dpp v17, v9, v33 row_newbcast:5 row_mask:0xf bank_mask:0xf
    v_dot2c_f32_bf16_dpp v18, v9, v34 row_newbcast:5 row_mask:0xf bank_mask:0xf
    v_dot2c_f32_bf16_dpp v19, v9, v35 row_newbcast:5 row_mask:0xf bank_mask:0xf
    v_dot2c_f32_bf16_dpp v20, v9, v36 row_newbcast:5 row_mask:0xf bank_mask:0xf
    v_dot2c_f32_bf16_dpp v21, v9, v37 row_newbcast:5 row_mask:0xf bank_mask:0xf
    v_dot2c_f32_bf16_dpp v22, v9, v38 row_newbcast:5 row_mask:0xf bank_mask:0xf
    v_dot2c_f32_bf16_dpp v23, v9, v39 row_newbcast:5 row_mask:0xf bank_mask:0xf
    s_waitcnt vmcnt(2)
    v_perm_b32 v24, v180, v176, s35
    v_perm_b32 v25, v180, v176, s36
    v_perm_b32 v26, v181, v177, s35
    v_perm_b32 v27, v181, v177, s36
    v_perm_b32 v28, v182, v178, s35
    v_perm_b32 v29, v182, v178, s36
    v_perm_b32 v30, v183, v179, s35
    v_perm_b32 v31, v183, v179, s36
    v_dot2c_f32_bf16_dpp v16, v9, v24 row_newbcast:3 row_mask:0xf bank_mask:0xf
    v_dot2c_f32_bf16_dpp v17, v9, v25 row_newbcast:3 row_mask:0xf bank_mask:0xf
    v_dot2c_f32_bf16_dpp v18, v9, v26 row_newbcast:3 row_mask:0xf bank_mask:0xf
    v_dot2c_f32_bf16_dpp v19, v9, v27 row_newbcast:3 row_mask:0xf bank_mask:0xf
    v_dot2c_f32_bf16_dpp v20, v9, v28 row_newbcast:3 row_mask:0xf bank_mask:0xf
    v_dot2c_f32_bf16_dpp v21, v9, v29 row_newbcast:3 row_mask:0xf bank_mask:0xf
    v_dot2c_f32_bf16_dpp v22, v9, v30 row_newbcast:3 row_mask:0xf bank_mask:0xf
    v_dot2c_f32_bf16_dpp v23, v9, v31 row_newbcast:3 row_mask:0xf bank_mask:0xf
    s_waitcnt vmcnt(0)
    v_perm_b32 v32, v188, v184, s35
    v_perm_b32 v33, v188, v184, s36
    v_perm_b32 v34, v189, v185, s35
    v_perm_b32 v35, v189, v185, s36
    v_perm_b32 v36, v190, v186, s35
    v_perm_b32 v37, v190, v186, s36
    v_perm_b32 v38, v191, v187, s35
    v_perm_b32 v39, v191, v187, s36
    v_dot2c_f32_bf16_dpp v16, v9, v32 row_newbcast:7 row_mask:0xf bank_mask:0xf
    v_dot2c_f32_bf16_dpp v17, v9, v33 row_newbcast:7 row_mask:0xf bank_mask:0xf
    v_dot2c_f32_bf16_dpp v18, v9, v34 row_newbcast:7 row_mask:0xf bank_mask:0xf
    v_dot2c_f32_bf16_dpp v19, v9, v35 row_newbcast:7 row_mask:0xf bank_mask:0xf
    v_dot2c_f32_bf16_dpp v20, v9, v36 row_newbcast:7 row_mask:0xf bank_mask:0xf
    v_dot2c_f32_bf16_dpp v21, v9, v37 row_newbcast:7 row_mask:0xf bank_mask:0xf
    v_dot2c_f32_bf16_dpp v22, v9, v38 row_newbcast:7 row_mask:0xf bank_mask:0xf
    v_dot2c_f32_bf16_dpp v23, v9, v39 row_newbcast:7 row_mask:0xf bank_mask:0xf
    v_permlane32_swap_b32 v16, v20
    v_permlane32_swap_b32 v17, v21
    v_permlane32_swap_b32 v18, v22
    v_permlane32_swap_b32 v19, v23
    v_add_f32 v16, v16, v20
    v_add_f32 v17, v17, v21
    v_add_f32 v18, v18, v22
    v_add_f32 v19, v19, v23
    s_nop 0
    v_permlane16_swap_b32 v16, v18
    v_permlane16_swap_b32 v17, v19
    v_add_f32 v16, v16, v18
    v_add_f32 v17, v17, v19
    v_mul_f32 v16, v16, v42
    v_mul_f32 v17, v17, v42
    ds_write_b64 v40, v[16:17] offset:3072
    s_waitcnt lgkmcnt(0)
    s_barrier
    s_branch L_fin
L_end:
    s_endpgm
L_code_end:
.section .rodata,"a"
.p2align 6
.amdhsa_kernel gated_mix__gqa_block_cached__geglu_ffn__decode_kernel
  .amdhsa_next_free_vgpr 256
  .amdhsa_next_free_sgpr 102
  .amdhsa_accum_offset 256
  .amdhsa_group_segment_fixed_size 0
  .amdhsa_kernarg_size 104
  .amdhsa_user_sgpr_count 2
  .amdhsa_user_sgpr_kernarg_segment_ptr 1
  .amdhsa_system_sgpr_workgroup_id_x 1
  .amdhsa_float_denorm_mode_32 3
  .amdhsa_float_denorm_mode_16_64 3
.end_amdhsa_kernel
```
